```python
import torch

def _softmax(x, axis=-1):
    return torch.softmax(x, dim=axis)

def _gelu(x):
    return torch.nn.functional.gelu(x, approximate='tanh')

def _silu(x):
    return torch.nn.functional.silu(x)

def _sigmoid(x):
    return torch.sigmoid(x)

def _layernorm(x, axis=-1, eps=1e-05):
    m = x.mean(dim=axis, keepdim=True)
    v = x.var(dim=axis, keepdim=True, unbiased=False)
    return (x - m) / torch.sqrt(v + eps)

def _scatter_add(tgt, idx, src, axis=0):
    return tgt.clone().index_add_(axis, idx, src)

def _segment_sum(src, seg, n):
    out = torch.zeros((n,) + src.shape[1:], dtype=src.dtype)
    return out.index_add_(0, seg, src)

def _pad(x, pw):
    flat = tuple((v for pair in reversed(pw) for v in pair))
    return torch.nn.functional.pad(x, flat)
kernel_name = 'adaLN_cond__sliding_block_cached__glu_gated_geglu__decode'

def setup_inputs():

    _w = lambda a: (lambda t: t.to(torch.bfloat16) if t.is_floating_point() else t)(torch.as_tensor(a))

    def _A_setup():
        B, Sq, D = (1, 1, 512)
        Hq, Hkv, Sk, Dh = (32, 8, 65536, 128)
        assert Hq % Hkv == 0, (Hq, Hkv)
        return {'x': _w((lambda *s: torch.randn(*s, dtype=torch.bfloat16) * 0.05)(B, Sq, D)), 'k_cache': _w((lambda *s: torch.randn(*s, dtype=torch.bfloat16) * 0.8)(B, Hkv, Sk, Dh)), 'v_cache': _w((lambda *s: torch.randn(*s, dtype=torch.bfloat16) * 3.2)(B, Hkv, Sk, Dh)), 'wq': _w((lambda *s: torch.randn(*s, dtype=torch.bfloat16) * 0.8)(D, Hq * Dh) * D ** (-0.5)), 'wo': _w((lambda *s: torch.randn(*s, dtype=torch.bfloat16) * 3.2)(Hq * Dh, D) * (Hq * Dh) ** (-0.5))}
    _A_in = _A_setup()

    def _B_setup():
        B, S, Dm, Df = (1, 1, 512, 1792)
        return {'x': _w((lambda *s: torch.randn(*s, dtype=torch.bfloat16) * 0.05)(B, S, Dm)), 'w_gate': _w((lambda *s: torch.randn(*s, dtype=torch.bfloat16) * 3.2)(Dm, Df) * Dm ** (-0.5)), 'w_up': _w((lambda *s: torch.randn(*s, dtype=torch.bfloat16) * 3.2)(Dm, Df) * Dm ** (-0.5)), 'w_down': _w((lambda *s: torch.randn(*s, dtype=torch.bfloat16) * 3.2)(Df, Dm) * Df ** (-0.5))}
    _B_in = _B_setup()
    return {'A_x': _A_in['x'], 'A_k_cache': _A_in['k_cache'], 'A_v_cache': _A_in['v_cache'], 'A_wq': _A_in['wq'], 'A_wo': _A_in['wo'], 'B_x': _B_in['x'], 'B_w_gate': _B_in['w_gate'], 'B_w_up': _B_in['w_up'], 'B_w_down': _B_in['w_down'], 'c': _w((lambda *s: torch.randn(*s, dtype=torch.bfloat16) * 0.4)(1, 512) * 8.0), 'w_mod': _w((lambda *s: torch.randn(*s, dtype=torch.bfloat16) * 0.4)(512, 6 * 512) * 512 ** (-0.5) * 8.0)}

def reference(A_x, A_k_cache, A_v_cache, A_wq, A_wo, B_x, B_w_gate, B_w_up, B_w_down, c, w_mod):

    def _A_ref(x, k_cache, v_cache, wq, wo):
        B, Sq, D = x.shape
        Hq, Dh = (32, 128)
        Hkv, Sk = (k_cache.shape[1], k_cache.shape[2])
        W = min(4096, max(256, Sk // 4))
        rep = Hq // Hkv
        q = (lambda x, *d: x.permute(*d))((x @ wq).reshape(B, Sq, Hq, Dh), 0, 2, 1, 3)
        k = (lambda x, n, axis: torch.repeat_interleave(x, n, dim=axis))(k_cache[:, :, Sk - W:, :], rep, axis=1)
        v = (lambda x, n, axis: torch.repeat_interleave(x, n, dim=axis))(v_cache[:, :, Sk - W:, :], rep, axis=1)
        scores = torch.einsum('bhqd,bhkd->bhqk', q, k) * Dh ** (-0.5)
        p = _softmax(scores, axis=-1)
        o = torch.einsum('bhqk,bhkd->bhqd', p, v)
        return (lambda x, *d: x.permute(*d))(o, 0, 2, 1, 3).reshape(B, Sq, Hq * Dh) @ wo

    def _B_ref(x, w_gate, w_up, w_down):
        g = torch.einsum('bsd,df->bsf', x, w_gate)
        u = torch.einsum('bsd,df->bsf', x, w_up)
        h = _gelu(g) * u
        return torch.einsum('bsf,fd->bsd', h, w_down)
    x = A_x
    mod = (_silu(c) @ w_mod).reshape(c.shape[0], 6, 1, -1)
    sa, ca, ga, sb, cb, gb = (mod[:, 0].clone(), mod[:, 1].clone(), mod[:, 2].clone(), mod[:, 3].clone(), mod[:, 4].clone(), mod[:, 5].clone())
    h = _layernorm(x, axis=-1) * (1 + ca) + sa
    x = x + ga * _A_ref(h, A_k_cache, A_v_cache, A_wq, A_wo)
    h = _layernorm(x, axis=-1) * (1 + cb) + sb
    x = x + gb * _B_ref(h, B_w_gate, B_w_up, B_w_down)
    return x
```

```asm
; @launch grid=(256,1,1) block=(512,1,1) lds=135168
.amdgcn_target "amdgcn-amd-amdhsa--gfx950"
.text
.globl adaLN_cond__sliding_block_cached__glu_gated_geglu__decode_kernel
.p2align 8
.type adaLN_cond__sliding_block_cached__glu_gated_geglu__decode_kernel,@function
adaLN_cond__sliding_block_cached__glu_gated_geglu__decode_kernel:
  s_load_dwordx16 s[8:23], s[0:1], 0
  s_load_dwordx8 s[24:31], s[0:1], 64
  s_load_dwordx4 s[32:35], s[0:1], 96
  v_and_b32 v1, 63, v0
  v_lshrrev_b32 v2, 6, v0
  s_and_b32 s36, s2, 7
  s_lshr_b32 s37, s2, 3
  v_readfirstlane_b32 s38, v2
  s_cmp_ge_u32 s37, 32
  s_nop 2
  s_cbranch_scc1 L_exit
  s_cmp_lg_u32 s38, 7
  s_cbranch_scc1 L_pf_1
  s_cmp_ge_u32 s37, 16
  s_cbranch_scc1 L_pf_1
  s_getpc_b64 s[72:73]
L_pc_2:
  v_and_b32 v240, 7, v1
  v_lshlrev_b32 v240, 11, v240
  s_lshl_b32 s3, s37, 7
  v_add_u32 v240, s3, v240
  v_min_u32 v240, L_codeend-L_pc_2-4, v240
  global_load_dword v241, v240, s[72:73]
  s_nop 0
L_pf_1:
  s_movk_i32 s47, 1024
  s_mov_b32 s51, 0x20000
  s_cmp_ge_u32 s37, 24
  s_cbranch_scc1 L_MH
  s_cmp_ge_u32 s37, 16
  s_cbranch_scc1 L_B
  s_cmp_ge_u32 s38, 4
  s_cbranch_scc1 L_T
  v_lshrrev_b32 v5, 4, v1
  v_and_b32 v7, 15, v1
  v_xor_b32 v6, v5, v7
  v_lshlrev_b32 v6, 4, v6
  v_lshl_add_u32 v14, v5, 8, v6
  v_xor_b32 v15, 64, v14
  v_xor_b32 v16, 0x80, v14
  v_xor_b32 v17, 64, v16
  s_lshl_b32 s76, s36, 24
  s_lshl_b32 s3, s37, 12
  s_add_u32 s76, s76, s3
  s_lshl_b32 s3, s38, 10
  s_add_u32 s76, s76, s3
  s_add_u32 s76, s76, 0xf00000
  s_lshl_b32 m0, s38, 14
  s_mov_b32 s50, 0x8000000
  s_mov_b32 s75, 0x11000
  s_mov_b32 s78, 0
  s_mov_b32 s79, 0
  s_waitcnt lgkmcnt(0)
  s_mov_b64 s[48:49], s[10:11]
L_Tld:
  s_xor_b32 s77, s76, s78
  buffer_load_dwordx4 v14, s[48:51], s77 offen nt lds
  s_add_u32 m0, m0, s47
  s_add_u32 s78, s78, s75
  s_xor_b32 s77, s76, s78
  buffer_load_dwordx4 v15, s[48:51], s77 offen nt lds
  s_add_u32 m0, m0, s47
  s_add_u32 s78, s78, s75
  s_xor_b32 s77, s76, s78
  buffer_load_dwordx4 v16, s[48:51], s77 offen nt lds
  s_add_u32 m0, m0, s47
  s_add_u32 s78, s78, s75
  s_xor_b32 s77, s76, s78
  buffer_load_dwordx4 v17, s[48:51], s77 offen nt lds
  s_add_u32 m0, m0, s47
  s_add_u32 s78, s78, s75
  s_cmp_lt_u32 s78, 0x110000
  s_cbranch_scc1 L_Tld
  s_cmp_lg_u32 s79, 0
  s_cbranch_scc1 L_Tld_done
  v_lshlrev_b32 v6, 1, v5
  v_xor_b32 v6, v6, v7
  v_lshlrev_b32 v6, 4, v6
  v_lshl_add_u32 v14, v5, 8, v6
  v_xor_b32 v15, 0x80, v14
  v_mov_b32 v16, v14
  v_mov_b32 v17, v15
  s_add_u32 m0, m0, 49152
  s_mov_b64 s[48:49], s[12:13]
  s_mov_b32 s78, 0
  s_mov_b32 s79, 1
  s_branch L_Tld
L_Tld_done:
  s_waitcnt vmcnt(16)
  s_barrier
  s_branch L_T
L_B:
  s_sub_u32 s74, s37, 16
  v_lshrrev_b32 v6, 3, v1
  v_mul_u32_u24 v4, 8192, v6
  v_and_b32 v6, 2, v6
  v_and_b32 v7, 7, v1
  v_xor_b32 v6, v6, v7
  v_lshl_add_u32 v4, v6, 4, v4
  v_xor_b32 v5, 64, v4
  s_lshl_b32 s77, s38, 19
  s_lshl_b32 s3, s36, 10
  s_add_u32 s77, s77, s3
  s_lshl_b32 s3, s74, 7
  s_add_u32 s77, s77, s3
  s_lshl_b32 m0, s38, 13
  s_mov_b32 s50, 0x400000
  s_mov_b32 s75, 0x10000
  s_mov_b32 s78, 0
  s_waitcnt lgkmcnt(0)
  s_mov_b64 s[48:49], s[14:15]
L_Bld:
  buffer_load_dwordx4 v4, s[48:51], s77 offen nt lds
  s_add_u32 m0, m0, s47
  s_add_u32 s77, s77, s75
  buffer_load_dwordx4 v5, s[48:51], s77 offen nt lds
  s_add_u32 m0, m0, s47
  s_add_u32 s77, s77, s75
  s_add_u32 s78, s78, 1
  s_cmp_lt_u32 s78, 4
  s_cbranch_scc1 L_Bld
  s_branch L_Bbody
L_MH:
  s_sub_u32 s74, s37, 24
  s_and_b32 s75, s74, 1
  s_lshr_b32 s76, s74, 1
  v_lshrrev_b32 v6, 3, v1
  v_mul_u32_u24 v4, 6144, v6
  v_and_b32 v6, 2, v6
  v_and_b32 v7, 7, v1
  v_xor_b32 v6, v6, v7
  v_lshl_add_u32 v4, v6, 4, v4
  v_xor_b32 v5, 64, v4
  s_lshl_b32 s77, s76, 7
  s_lshl_b32 s3, s38, 4
  s_add_u32 s77, s77, s3
  s_mul_i32 s77, s77, 6144
  s_lshl_b32 s3, s75, 10
  s_add_u32 s77, s77, s3
  s_lshl_b32 s3, s36, 7
  s_add_u32 s77, s77, s3
  s_lshl_b32 s78, s38, 11
  s_lshl_b32 s79, s76, 8
  v_lshl_add_u32 v2, v1, 2, s79
  s_mov_b32 s50, 0x300000
  s_waitcnt lgkmcnt(0)
  s_mov_b64 s[48:49], s[28:29]
  s_cmp_lg_u32 s38, 7
  s_cbranch_scc1 L_notc_3
  global_load_dword v3, v2, s[26:27]
L_notc_3:
  s_mov_b32 m0, s78
  s_nop 0
  buffer_load_dwordx4 v4, s[48:51], s77 offen nt lds
  s_add_u32 m0, m0, 1024
  s_add_u32 s77, s77, 49152
  buffer_load_dwordx4 v5, s[48:51], s77 offen nt lds
  s_load_dword s46, s[34:35], 0
  s_cmp_lg_u32 s38, 7
  s_cbranch_scc1 L_notc_4
  s_mov_b32 s44, 0xffff0000
  v_lshlrev_b32 v2, 2, v1
  s_waitcnt vmcnt(2)
  v_lshlrev_b32 v14, 16, v3
  v_and_b32 v15, s44, v3
  v_mul_f32 v16, 0xbfb8aa3b, v14
  v_mul_f32 v17, 0xbfb8aa3b, v15
  v_exp_f32 v16, v16
  v_exp_f32 v17, v17
  v_add_f32 v16, 1.0, v16
  v_add_f32 v17, 1.0, v17
  v_rcp_f32 v16, v16
  v_rcp_f32 v17, v17
  v_mul_f32 v14, v14, v16
  v_mul_f32 v15, v15, v17
  v_cvt_pk_bf16_f32 v3, v14, v15
  ds_write_b32 v2, v3 offset:16384
  s_nop 0
L_notc_4:
  s_mov_b32 s40, 0x07060500
  s_mov_b32 s41, 0x07060501
  s_mov_b32 s42, 0x07060502
  s_mov_b32 s43, 0x07060503
  s_mov_b32 s44, 0xffff0000
  s_mov_b32 s70, 0xaaaaaaaa
  s_mov_b32 s71, 0xaaaaaaaa
  s_mov_b32 s18, 0x00010001
  s_mov_b32 s19, 0x00010001
  s_add_u32 s64, s34, 0x100000
  s_addc_u32 s65, s35, 0
  s_and_b32 s79, s38, 3
  v_lshrrev_b32 v8, 4, v1
  v_bfe_u32 v9, v1, 2, 2
  v_lshl_add_u32 v7, v8, 3, v9
  v_lshlrev_b32 v7, 7, v7
  v_lshrrev_b32 v9, 1, v9
  v_and_b32 v8, 1, v8
  v_lshl_or_b32 v8, v8, 1, v9
  v_xor_b32 v8, s79, v8
  v_lshl_add_u32 v7, v8, 5, v7
  v_and_b32 v8, 3, v1
  v_lshl_add_u32 v7, v8, 3, v7
  v_and_b32 v8, 48, v1
  v_add_u32 v8, 16384, v8
  s_lshl_b32 s77, s36, 12
  s_lshl_b32 s3, s74, 9
  s_add_u32 s77, s77, s3
  s_lshl_b32 s3, s79, 7
  s_add_u32 s77, s77, s3
  s_add_u32 s77, s77, 0x60000
  v_and_b32 v30, 48, v1
  v_lshlrev_b32 v30, 1, v30
  v_and_b32 v9, 1, v1
  v_lshl_add_u32 v30, v9, 4, v30
  v_add_u32 v30, s77, v30
  s_cmp_lg_u32 s37, 31
  s_cbranch_scc1 L_nothx_5
  s_cmp_lg_u32 s38, 4
  s_cbranch_scc1 L_nothx_5
  s_lshl_b32 s77, s36, 12
  s_add_u32 s77, s77, 0x60000
  v_lshl_add_u32 v29, v1, 6, s77
  global_load_dword v32, v29, s[34:35] sc1
  v_lshlrev_b32 v2, 4, v1
  global_load_dwordx4 v[24:27], v2, s[8:9]
  s_lshl_b32 s77, s36, 7
  v_lshl_add_u32 v2, v1, 1, s77
  global_load_ushort v28, v2, s[8:9]
  s_waitcnt lgkmcnt(0)
  s_and_b32 s3, s46, 0x7f7f7f7f
  s_add_u32 s3, s3, 0x01010101
  s_and_b32 s39, s46, 0x80808080
  s_xor_b32 s39, s39, s3
  v_mov_b32 v10, s39
  v_and_b32 v13, 3, v1
  v_lshlrev_b32 v13, 3, v13
  v_lshrrev_b32 v11, v13, v10
  v_and_b32 v13, 1, v1
  v_lshlrev_b32 v13, 4, v13
  v_lshrrev_b32 v12, v13, v10
  s_waitcnt vmcnt(3)
  s_branch L_donehx_6
L_nothx_5:
  s_waitcnt lgkmcnt(0)
  s_and_b32 s3, s46, 0x7f7f7f7f
  s_add_u32 s3, s3, 0x01010101
  s_and_b32 s39, s46, 0x80808080
  s_xor_b32 s39, s39, s3
  v_mov_b32 v10, s39
  v_and_b32 v13, 3, v1
  v_lshlrev_b32 v13, 3, v13
  v_lshrrev_b32 v11, v13, v10
  v_and_b32 v13, 1, v1
  v_lshlrev_b32 v13, 4, v13
  v_lshrrev_b32 v12, v13, v10
  v_mov_b32 v69, v10
  v_mov_b32 v71, v10
  s_waitcnt vmcnt(0) lgkmcnt(0)
  s_nop 0
L_donehx_6:
  s_barrier
  s_cmp_ge_u32 s38, 4
  s_cbranch_scc1 L_skipA_7
  ds_read_b64_tr_b16 v[32:33], v7 offset:0
  ds_read_b64_tr_b16 v[34:35], v7 offset:512
  ds_read_b128 v[48:51], v8 offset:0
  ds_read_b64_tr_b16 v[36:37], v7 offset:4096
  ds_read_b64_tr_b16 v[38:39], v7 offset:4608
  ds_read_b128 v[52:55], v8 offset:64
  ds_read_b64_tr_b16 v[40:41], v7 offset:8192
  ds_read_b64_tr_b16 v[42:43], v7 offset:8704
  ds_read_b128 v[56:59], v8 offset:128
  ds_read_b64_tr_b16 v[44:45], v7 offset:12288
  ds_read_b64_tr_b16 v[46:47], v7 offset:12800
  ds_read_b128 v[60:63], v8 offset:192
  s_waitcnt lgkmcnt(9)
  v_mfma_f32_16x16x32_bf16 v[64:67], v[32:35], v[48:51], 0
  s_waitcnt lgkmcnt(6)
  v_mfma_f32_16x16x32_bf16 v[64:67], v[36:39], v[52:55], v[64:67]
  s_waitcnt lgkmcnt(3)
  v_mfma_f32_16x16x32_bf16 v[64:67], v[40:43], v[56:59], v[64:67]
  s_waitcnt lgkmcnt(0)
  v_mfma_f32_16x16x32_bf16 v[64:67], v[44:47], v[60:63], v[64:67]
  s_nop 7
  v_cndmask_b32 v68, v64, v66, s[70:71]
  v_cndmask_b32 v70, v65, v67, s[70:71]
  s_mov_b32 exec_lo, 0x00030003
  s_mov_b32 exec_hi, 0x00030003
  global_store_dwordx4 v30, v[68:71], s[34:35]
  s_cmp_eq_u32 s37, 31
  s_cbranch_scc1 L_nog_8
  global_store_dwordx4 v30, v[68:71], s[64:65] sc1
  s_nop 1
L_nog_8:
  s_mov_b64 exec, -1
L_skipA_7:
  s_cmp_lg_u32 s37, 31
  s_cbranch_scc1 L_M
L_H:
  s_cmp_lg_u32 s38, 4
  s_cbranch_scc1 L_exit
  v_mov_b32 v40, 0x3f803f80
  v_mov_b32 v41, 0x3b000000
  s_waitcnt vmcnt(0)
  v_dot2_f32_bf16 v42, v24, v40, 0
  v_dot2_f32_bf16 v43, v24, v24, 0
  v_dot2_f32_bf16 v42, v25, v40, v42
  v_dot2_f32_bf16 v43, v25, v25, v43
  v_dot2_f32_bf16 v42, v26, v40, v42
  v_dot2_f32_bf16 v43, v26, v26, v43
  v_dot2_f32_bf16 v42, v27, v40, v42
  v_dot2_f32_bf16 v43, v27, v27, v43
  s_nop 2
  v_add_f32_dpp v42, v42, v42 quad_perm:[1,0,3,2] row_mask:0xf bank_mask:0xf
  v_add_f32_dpp v43, v43, v43 quad_perm:[1,0,3,2] row_mask:0xf bank_mask:0xf
  s_nop 0
  v_add_f32_dpp v42, v42, v42 quad_perm:[2,3,0,1] row_mask:0xf bank_mask:0xf
  v_add_f32_dpp v43, v43, v43 quad_perm:[2,3,0,1] row_mask:0xf bank_mask:0xf
  s_nop 0
  v_add_f32_dpp v42, v42, v42 row_half_mirror row_mask:0xf bank_mask:0xf
  v_add_f32_dpp v43, v43, v43 row_half_mirror row_mask:0xf bank_mask:0xf
  s_nop 0
  v_add_f32_dpp v42, v42, v42 row_mirror row_mask:0xf bank_mask:0xf
  v_add_f32_dpp v43, v43, v43 row_mirror row_mask:0xf bank_mask:0xf
  s_nop 1
  v_permlane32_swap_b32 v42, v43
  v_add_f32 v42, v42, v43
  v_mov_b32 v43, v42
  s_nop 1
  v_permlane16_swap_b32 v42, v43
  v_add_f32 v42, v42, v43
  s_nop 0
  v_readlane_b32 s77, v42, 0
  v_readlane_b32 s78, v42, 32
  s_nop 0
  v_mul_f32 v44, s77, v41
  v_mul_f32 v45, s78, v41
  v_fma_f32 v45, -v44, v44, v45
  v_max_f32 v45, 0, v45
  v_cvt_pk_bf16_f32 v46, v44, v45
  v_lshlrev_b32 v44, 16, v46
  v_and_b32 v45, s44, v46
  v_add_f32 v45, 0x3727c5ac, v45
  v_cvt_pk_bf16_f32 v45, v45, v45
  v_and_b32 v45, s44, v45
  v_sqrt_f32 v45, v45
  s_nop 0
  v_cvt_pk_bf16_f32 v45, v45, v45
  v_and_b32 v45, s44, v45
  v_rcp_f32 v45, v45
  v_lshlrev_b32 v28, 16, v28
  v_sub_f32 v28, v28, v44
  v_cvt_pk_bf16_f32 v28, v28, v28
  v_and_b32 v28, s44, v28
  v_mul_f32 v28, v28, v45
  v_cvt_pk_bf16_f32 v28, v28, v28
  v_and_b32 v28, s44, v28
  s_lshl_b32 s77, s36, 12
  s_add_u32 s77, s77, 0x60000
  v_lshl_add_u32 v2, v1, 3, s77
  s_lshl_b32 s77, s36, 8
  s_add_u32 s77, s77, 0x8000
  v_lshl_add_u32 v3, v1, 2, s77
  s_mov_b32 s45, 0
  s_mov_b64 s[66:67], s[34:35]
L_poll_9:
  s_mov_b64 exec, -1
  global_load_dwordx2 v[64:65], v2, s[66:67] offset:0 sc1
  global_load_dwordx2 v[66:67], v2, s[66:67] offset:512 sc1
  global_load_dwordx2 v[68:69], v2, s[66:67] offset:1024 sc1
  global_load_dwordx2 v[70:71], v2, s[66:67] offset:1536 sc1
  global_load_dwordx2 v[72:73], v2, s[66:67] offset:2048 sc1
  global_load_dwordx2 v[74:75], v2, s[66:67] offset:2560 sc1
  global_load_dwordx2 v[76:77], v2, s[66:67] offset:3072 sc1
  global_load_dwordx2 v[78:79], v2, s[34:35] offset:3584 sc1
  s_add_u32 s45, s45, 1
  s_and_b32 s3, s45, 31
  s_cmp_eq_u32 s3, 31
  s_cselect_b64 s[66:67], s[64:65], s[34:35]
  s_cmp_gt_u32 s45, 400000
  s_cbranch_scc1 L_bail_11
  s_waitcnt vmcnt(0)
  v_cmpx_eq_u32 vcc, v65, v10
  v_cmpx_eq_u32 vcc, v67, v10
  v_cmpx_eq_u32 vcc, v69, v10
  v_cmpx_eq_u32 vcc, v71, v10
  v_cmpx_eq_u32 vcc, v73, v10
  v_cmpx_eq_u32 vcc, v75, v10
  v_cmpx_eq_u32 vcc, v77, v10
  v_cmpx_eq_u32 vcc, v79, v10
  s_cmp_eq_u64 exec, -1
  s_cbranch_scc0 L_poll_9
L_pdone_10:
  v_add_f32 v48, v64, v68
  v_add_f32 v49, v66, v70
  v_add_f32 v52, v72, v76
  v_add_f32 v53, v74, v78
  v_add_f32 v48, v48, v52
  v_add_f32 v49, v49, v53
  v_cvt_pk_bf16_f32 v50, v48, v49
  v_lshlrev_b32 v48, 16, v50
  v_and_b32 v49, s44, v50
  v_add_f32 v49, 1.0, v49
  v_cvt_pk_bf16_f32 v49, v49, v49
  v_and_b32 v49, s44, v49
  v_mul_f32 v28, v28, v49
  v_cvt_pk_bf16_f32 v28, v28, v28
  v_and_b32 v28, s44, v28
  v_add_f32 v28, v28, v48
  v_cvt_pk_bf16_f32 v28, v28, v28
  v_perm_b32 v28, v28, v11, s40
  global_store_dword v3, v28, s[34:35] sc1
  s_lshl_b32 s77, s36, 16
  s_add_u32 s77, s77, 0x80000
  v_lshl_add_u32 v2, v1, 10, s77
  global_load_dword v32, v2, s[34:35] offset:0 sc1
  global_load_dword v33, v2, s[34:35] offset:128 sc1
  global_load_dword v34, v2, s[34:35] offset:256 sc1
  global_load_dword v35, v2, s[34:35] offset:384 sc1
  global_load_dword v36, v2, s[34:35] offset:512 sc1
  s_waitcnt vmcnt(0)
  s_endpgm
L_Bbody:
  s_load_dword s46, s[34:35], 0
  s_mov_b32 s40, 0x07060500
  s_mov_b32 s41, 0x07060501
  s_mov_b32 s42, 0x07060502
  s_mov_b32 s43, 0x07060503
  s_mov_b32 s44, 0xffff0000
  s_mov_b32 s70, 0xaaaaaaaa
  s_mov_b32 s71, 0xaaaaaaaa
  s_mov_b32 s18, 0x00010001
  s_mov_b32 s19, 0x00010001
  s_add_u32 s64, s34, 0x100000
  s_addc_u32 s65, s35, 0
  s_mov_b32 s52, s28
  s_mov_b32 s53, s29
  s_mov_b32 s54, 0x300000
  s_mov_b32 s55, 0x20000
  s_lshl_b32 s75, s36, 3
  s_add_u32 s75, s75, s74
  s_and_b32 s76, s75, 1
  s_lshl_b32 s77, s76, 9
  v_and_b32 v2, 127, v0
  v_lshl_add_u32 v3, v2, 2, s77
  s_cmp_lt_u32 s38, 6
  s_cbranch_scc1 L_nc_12
  global_load_dword v24, v3, s[26:27]
L_nc_12:
  s_and_b32 s79, s38, 3
  v_lshrrev_b32 v8, 4, v1
  v_bfe_u32 v9, v1, 2, 2
  v_lshl_add_u32 v7, v8, 3, v9
  v_lshlrev_b32 v7, 7, v7
  v_lshrrev_b32 v9, 1, v9
  v_and_b32 v8, 1, v8
  v_lshl_or_b32 v8, v8, 1, v9
  v_xor_b32 v8, s79, v8
  v_lshl_add_u32 v7, v8, 5, v7
  v_and_b32 v8, 3, v1
  v_lshl_add_u32 v7, v8, 3, v7
  v_and_b32 v8, 48, v1
  v_add_u32 v8, 98304, v8
  v_lshrrev_b32 v16, 3, v1
  v_mul_u32_u24 v14, 6144, v16
  v_and_b32 v16, 2, v16
  v_and_b32 v17, 7, v1
  v_xor_b32 v16, v16, v17
  v_lshl_add_u32 v14, v16, 4, v14
  v_xor_b32 v15, 64, v14
  s_waitcnt lgkmcnt(0)
  s_and_b32 s3, s46, 0x7f7f7f7f
  s_add_u32 s3, s3, 0x01010101
  s_and_b32 s39, s46, 0x80808080
  s_xor_b32 s39, s39, s3
  v_mov_b32 v10, s39
  v_and_b32 v13, 3, v1
  v_lshlrev_b32 v13, 3, v13
  v_lshrrev_b32 v11, v13, v10
  v_and_b32 v13, 1, v1
  v_lshlrev_b32 v13, 4, v13
  v_lshrrev_b32 v12, v13, v10
  s_lshl_b32 s77, s38, 8
  s_add_u32 s77, s77, 0x8000
  v_lshl_add_u32 v9, v1, 2, s77
  s_lshl_b32 s77, s38, 7
  s_add_u32 s77, s77, 0x18000
  v_lshl_add_u32 v18, v1, 1, s77
  s_lshl_b32 s77, s75, 8
  s_lshl_b32 s3, s79, 6
  s_add_u32 s77, s77, s3
  v_and_b32 v19, 48, v1
  v_add_u32 v19, s77, v19
  v_lshlrev_b32 v21, 1, v19
  v_and_b32 v20, 1, v1
  v_lshl_add_u32 v21, v20, 4, v21
  v_add_u32 v21, 425984, v21
  v_add_u32 v19, 36864, v19
  v_lshlrev_b32 v2, 2, v2
  v_add_u32 v2, 99328, v2
  s_lshl_b32 s72, s76, 8
  s_lshl_b32 s3, s38, 5
  s_add_u32 s72, s72, s3
  s_mul_i32 s72, s72, 6144
  s_lshr_b32 s3, s75, 1
  s_lshl_b32 s3, s3, 7
  s_add_u32 s72, s72, s3
  s_add_u32 s72, s72, 2048
  s_lshl_b32 s73, s38, 12
  s_add_u32 s73, s73, 0x10000
  s_lshl_b32 s77, s36, 19
  s_lshl_b32 s3, s74, 16
  s_add_u32 s77, s77, s3
  s_add_u32 s77, s77, 0x180
  v_lshl_add_u32 v16, v1, 10, s77
  s_waitcnt vmcnt(0)
  s_cmp_lt_u32 s38, 6
  s_cbranch_scc1 L_nc_13
  v_lshlrev_b32 v25, 16, v24
  v_and_b32 v26, s44, v24
  v_mul_f32 v27, 0xbfb8aa3b, v25
  v_mul_f32 v28, 0xbfb8aa3b, v26
  v_exp_f32 v27, v27
  v_exp_f32 v28, v28
  v_add_f32 v27, 1.0, v27
  v_add_f32 v28, 1.0, v28
  v_rcp_f32 v27, v27
  v_rcp_f32 v28, v28
  v_mul_f32 v25, v25, v27
  v_mul_f32 v26, v26, v28
  v_cvt_pk_bf16_f32 v24, v25, v26
  ds_write_b32 v2, v24
  s_nop 0
L_nc_13:
  s_barrier
  s_cmp_ge_u32 s38, 4
  s_cbranch_scc1 L_skipF_14
  ds_read_b64_tr_b16 v[32:33], v7 offset:0
  ds_read_b64_tr_b16 v[34:35], v7 offset:512
  ds_read_b64_tr_b16 v[36:37], v7 offset:4096
  ds_read_b64_tr_b16 v[38:39], v7 offset:4608
  ds_read_b64_tr_b16 v[40:41], v7 offset:8192
  ds_read_b64_tr_b16 v[42:43], v7 offset:8704
  ds_read_b64_tr_b16 v[44:45], v7 offset:12288
  ds_read_b64_tr_b16 v[46:47], v7 offset:12800
  ds_read_b64_tr_b16 v[48:49], v7 offset:16384
  ds_read_b64_tr_b16 v[50:51], v7 offset:16896
  ds_read_b64_tr_b16 v[52:53], v7 offset:20480
  ds_read_b64_tr_b16 v[54:55], v7 offset:20992
  ds_read_b64_tr_b16 v[56:57], v7 offset:24576
  ds_read_b64_tr_b16 v[58:59], v7 offset:25088
  ds_read_b64_tr_b16 v[60:61], v7 offset:28672
  ds_read_b64_tr_b16 v[62:63], v7 offset:29184
  ds_read_b64_tr_b16 v[64:65], v7 offset:32768
  ds_read_b64_tr_b16 v[66:67], v7 offset:33280
  ds_read_b64_tr_b16 v[68:69], v7 offset:36864
  ds_read_b64_tr_b16 v[70:71], v7 offset:37376
  ds_read_b64_tr_b16 v[72:73], v7 offset:40960
  ds_read_b64_tr_b16 v[74:75], v7 offset:41472
  ds_read_b64_tr_b16 v[76:77], v7 offset:45056
  ds_read_b64_tr_b16 v[78:79], v7 offset:45568
  ds_read_b64_tr_b16 v[80:81], v7 offset:49152
  ds_read_b64_tr_b16 v[82:83], v7 offset:49664
  ds_read_b64_tr_b16 v[84:85], v7 offset:53248
  ds_read_b64_tr_b16 v[86:87], v7 offset:53760
  ds_read_b64_tr_b16 v[88:89], v7 offset:57344
  ds_read_b64_tr_b16 v[90:91], v7 offset:57856
  ds_read_b64_tr_b16 v[92:93], v7 offset:61440
  ds_read_b64_tr_b16 v[94:95], v7 offset:61952
L_skipF_14:
  s_mov_b32 s45, 0
L_poll_15:
  s_mov_b64 exec, -1
  global_load_dword v24, v9, s[34:35] offset:0 sc1
  s_add_u32 s45, s45, 1
  s_cmp_gt_u32 s45, 400000
  s_cbranch_scc1 L_bail_17
  s_waitcnt vmcnt(0)
  v_cmpx_eq_u32_sdwa vcc, v24, v11 src0_sel:BYTE_0 src1_sel:BYTE_0
  s_cmp_eq_u64 exec, -1
  s_cbranch_scc0 L_poll_15
L_pdone_16:
  ds_write_b16_d16_hi v18, v24
  s_waitcnt lgkmcnt(0)
  s_barrier
  s_cmp_ge_u32 s38, 4
  s_cbranch_scc1 L_skipQ_18
  ds_read_b128 v[96:99], v8 offset:0
  ds_read_b128 v[100:103], v8 offset:64
  ds_read_b128 v[104:107], v8 offset:128
  ds_read_b128 v[108:111], v8 offset:192
  ds_read_b128 v[112:115], v8 offset:256
  ds_read_b128 v[116:119], v8 offset:320
  ds_read_b128 v[120:123], v8 offset:384
  ds_read_b128 v[124:127], v8 offset:448
  ds_read_b128 v[128:131], v8 offset:512
  ds_read_b128 v[132:135], v8 offset:576
  ds_read_b128 v[136:139], v8 offset:640
  ds_read_b128 v[140:143], v8 offset:704
  ds_read_b128 v[144:147], v8 offset:768
  ds_read_b128 v[148:151], v8 offset:832
  ds_read_b128 v[152:155], v8 offset:896
  ds_read_b128 v[156:159], v8 offset:960
  s_waitcnt lgkmcnt(15)
  v_mfma_f32_16x16x32_bf16 v[24:27], v[32:35], v[96:99], 0
  s_waitcnt lgkmcnt(14)
  v_mfma_f32_16x16x32_bf16 v[24:27], v[36:39], v[100:103], v[24:27]
  s_waitcnt lgkmcnt(13)
  v_mfma_f32_16x16x32_bf16 v[24:27], v[40:43], v[104:107], v[24:27]
  s_waitcnt lgkmcnt(12)
  v_mfma_f32_16x16x32_bf16 v[24:27], v[44:47], v[108:111], v[24:27]
  s_waitcnt lgkmcnt(11)
  v_mfma_f32_16x16x32_bf16 v[24:27], v[48:51], v[112:115], v[24:27]
  s_waitcnt lgkmcnt(10)
  v_mfma_f32_16x16x32_bf16 v[24:27], v[52:55], v[116:119], v[24:27]
  s_waitcnt lgkmcnt(9)
  v_mfma_f32_16x16x32_bf16 v[24:27], v[56:59], v[120:123], v[24:27]
  s_waitcnt lgkmcnt(8)
  v_mfma_f32_16x16x32_bf16 v[24:27], v[60:63], v[124:127], v[24:27]
  s_waitcnt lgkmcnt(7)
  v_mfma_f32_16x16x32_bf16 v[24:27], v[64:67], v[128:131], v[24:27]
  s_waitcnt lgkmcnt(6)
  v_mfma_f32_16x16x32_bf16 v[24:27], v[68:71], v[132:135], v[24:27]
  s_waitcnt lgkmcnt(5)
  v_mfma_f32_16x16x32_bf16 v[24:27], v[72:75], v[136:139], v[24:27]
  s_waitcnt lgkmcnt(4)
  v_mfma_f32_16x16x32_bf16 v[24:27], v[76:79], v[140:143], v[24:27]
  s_waitcnt lgkmcnt(3)
  v_mfma_f32_16x16x32_bf16 v[24:27], v[80:83], v[144:147], v[24:27]
  s_waitcnt lgkmcnt(2)
  v_mfma_f32_16x16x32_bf16 v[24:27], v[84:87], v[148:151], v[24:27]
  s_waitcnt lgkmcnt(1)
  v_mfma_f32_16x16x32_bf16 v[24:27], v[88:91], v[152:155], v[24:27]
  s_waitcnt lgkmcnt(0)
  v_mfma_f32_16x16x32_bf16 v[24:27], v[92:95], v[156:159], v[24:27]
  s_nop 7
  v_cvt_pk_bf16_f32 v24, v24, v24
  v_cvt_pk_bf16_f32 v25, v25, v25
  v_cvt_pk_bf16_f32 v26, v26, v26
  v_cvt_pk_bf16_f32 v27, v27, v27
  v_perm_b32 v28, v24, v10, s40
  v_perm_b32 v29, v25, v10, s41
  v_perm_b32 v30, v26, v10, s42
  v_perm_b32 v31, v27, v10, s43
  s_mov_b64 exec, s[18:19]
  global_store_dwordx4 v19, v[28:31], s[34:35]
  global_store_dwordx4 v19, v[28:31], s[64:65] sc1
  s_mov_b64 exec, -1
  s_nop 0
L_skipQ_18:
  s_barrier
  s_cmp_lg_u32 s38, 7
  s_cbranch_scc1 L_skipP_19
  global_load_dword v22, v16, s[16:17] nt
L_skipP_19:
  s_mov_b32 m0, s73
  s_nop 0
  buffer_load_dwordx4 v14, s[52:55], s72 offen nt lds
  s_add_u32 m0, m0, 1024
  s_add_u32 s72, s72, 49152
  buffer_load_dwordx4 v15, s[52:55], s72 offen nt lds
  s_add_u32 m0, m0, 1024
  s_add_u32 s72, s72, 49152
  buffer_load_dwordx4 v14, s[52:55], s72 offen nt lds
  s_add_u32 m0, m0, 1024
  s_add_u32 s72, s72, 49152
  buffer_load_dwordx4 v15, s[52:55], s72 offen nt lds
  s_waitcnt vmcnt(0)
  s_barrier
  s_cmp_ge_u32 s38, 4
  s_cbranch_scc1 L_exit
  v_add_u32 v7, 65536, v7
  ds_read_b128 v[96:99], v8 offset:1024
  ds_read_b128 v[100:103], v8 offset:1088
  ds_read_b128 v[104:107], v8 offset:1152
  ds_read_b128 v[108:111], v8 offset:1216
  ds_read_b128 v[112:115], v8 offset:1280
  ds_read_b128 v[116:119], v8 offset:1344
  ds_read_b128 v[120:123], v8 offset:1408
  ds_read_b128 v[124:127], v8 offset:1472
  ds_read_b64_tr_b16 v[32:33], v7 offset:0
  ds_read_b64_tr_b16 v[34:35], v7 offset:512
  ds_read_b64_tr_b16 v[36:37], v7 offset:4096
  ds_read_b64_tr_b16 v[38:39], v7 offset:4608
  ds_read_b64_tr_b16 v[40:41], v7 offset:8192
  ds_read_b64_tr_b16 v[42:43], v7 offset:8704
  ds_read_b64_tr_b16 v[44:45], v7 offset:12288
  ds_read_b64_tr_b16 v[46:47], v7 offset:12800
  ds_read_b64_tr_b16 v[48:49], v7 offset:16384
  ds_read_b64_tr_b16 v[50:51], v7 offset:16896
  ds_read_b64_tr_b16 v[52:53], v7 offset:20480
  ds_read_b64_tr_b16 v[54:55], v7 offset:20992
  ds_read_b64_tr_b16 v[56:57], v7 offset:24576
  ds_read_b64_tr_b16 v[58:59], v7 offset:25088
  ds_read_b64_tr_b16 v[60:61], v7 offset:28672
  ds_read_b64_tr_b16 v[62:63], v7 offset:29184
  v_mov_b32 v29, v10
  v_mov_b32 v31, v10
  s_waitcnt lgkmcnt(0)
  v_mfma_f32_16x16x32_bf16 v[24:27], v[32:35], v[96:99], 0
  v_mfma_f32_16x16x32_bf16 v[24:27], v[36:39], v[100:103], v[24:27]
  v_mfma_f32_16x16x32_bf16 v[24:27], v[40:43], v[104:107], v[24:27]
  v_mfma_f32_16x16x32_bf16 v[24:27], v[44:47], v[108:111], v[24:27]
  v_mfma_f32_16x16x32_bf16 v[24:27], v[48:51], v[112:115], v[24:27]
  v_mfma_f32_16x16x32_bf16 v[24:27], v[52:55], v[116:119], v[24:27]
  v_mfma_f32_16x16x32_bf16 v[24:27], v[56:59], v[120:123], v[24:27]
  v_mfma_f32_16x16x32_bf16 v[24:27], v[60:63], v[124:127], v[24:27]
  s_nop 7
  v_cndmask_b32 v28, v24, v26, s[70:71]
  v_cndmask_b32 v30, v25, v27, s[70:71]
  s_mov_b32 exec_lo, 0x00030003
  s_mov_b32 exec_hi, 0x00030003
  global_store_dwordx4 v21, v[28:31], s[34:35] sc1
  s_mov_b64 exec, -1
  s_endpgm
L_T:
  s_waitcnt lgkmcnt(0)
  s_load_dword s46, s[34:35], 0
  s_mov_b32 s40, 0x07060500
  s_mov_b32 s41, 0x07060501
  s_mov_b32 s42, 0x07060502
  s_mov_b32 s43, 0x07060503
  s_mov_b32 s44, 0xffff0000
  s_mov_b32 s70, 0xaaaaaaaa
  s_mov_b32 s71, 0xaaaaaaaa
  s_mov_b32 s18, 0x00010001
  s_mov_b32 s19, 0x00010001
  s_add_u32 s64, s34, 0x100000
  s_addc_u32 s65, s35, 0
  s_mov_b32 s56, s16
  s_mov_b32 s57, s17
  s_mov_b32 s58, 0x400000
  s_mov_b32 s59, 0x20000
  s_lshr_b32 s74, s37, 2
  s_and_b32 s75, s37, 3
  v_lshrrev_b32 v2, 4, v1
  v_and_b32 v3, 15, v1
  v_bfe_u32 v4, v1, 2, 2
  v_and_b32 v5, 3, v1
  v_and_b32 v6, 48, v1
  s_lshl_b32 s79, s38, 13
  s_lshl_b32 s77, s36, 11
  s_lshl_b32 s3, s38, 8
  s_add_u32 s77, s77, s3
  s_add_u32 s77, s77, 0x9000
  v_lshl_add_u32 v204, v1, 2, s77
  s_lshl_b32 s77, s36, 16
  s_lshl_b32 s3, s74, 14
  s_add_u32 s77, s77, s3
  s_lshl_b32 s3, s38, 7
  s_add_u32 s77, s77, s3
  s_add_u32 s77, s77, 0x80000
  v_lshrrev_b32 v7, 3, v1
  v_lshl_add_u32 v211, v7, 10, s77
  v_and_b32 v7, 7, v1
  s_cmp_ge_u32 s38, 4
  s_cselect_b32 s3, 4, 7
  v_cmp_le_u32 vcc, s3, v7
  s_nop 1
  v_cndmask_b32 v8, v7, 7, vcc
  v_lshl_add_u32 v211, v8, 4, v211
  v_add_u32 v212, 8192, v211
  v_lshlrev_b32 v8, 3, v7
  v_lshl_add_u32 v8, v2, 1, v8
  s_mul_i32 s3, s38, 56
  v_add_u32 v8, s3, v8
  v_mov_b32 v9, 256
  v_cndmask_b32 v8, v8, v9, vcc
  v_add_u32 v214, 132864, v8
  v_xor_b32 v7, v2, v3
  v_lshlrev_b32 v7, 4, v7
  v_lshl_add_u32 v7, v3, 8, v7
  v_add_u32 v220, s79, v7
  v_xor_b32 v221, 64, v220
  v_xor_b32 v222, 128, v220
  v_xor_b32 v223, 192, v220
  v_lshrrev_b32 v7, 2, v1
  v_lshlrev_b32 v8, 8, v7
  v_and_b32 v7, 7, v7
  v_lshl_add_u32 v8, v7, 5, v8
  v_lshl_add_u32 v8, v5, 3, v8
  s_add_u32 s3, s79, 65536
  v_add_u32 v201, s3, v8
  v_mul_u32_u24 v7, 320, v5
  v_add3_u32 v7, v7, v6, 0
  v_add_u32 v7, 131072, v7
  v_mov_b32 v8, 132352
  v_and_b32 v9, 8, v1
  v_cmp_eq_u32 s[4:5], 0, v9
  v_mov_b32 v202, v7
  v_and_b32 v9, 4, v1
  v_cmp_ne_u32 s[6:7], 0, v9
  s_lshr_b32 s77, s38, 1
  s_mul_i32 s77, s77, 320
  s_and_b32 s3, s38, 1
  s_lshl_b32 s3, s3, 7
  s_add_u32 s77, s77, s3
  s_add_u32 s77, s77, 131072
  v_lshl_add_u32 v205, v1, 1, s77
  v_mov_b32 v8, 0
  v_lshlrev_b32 v9, 2, v1
  v_add_u32 v9, 132352, v9
  ds_write_b32 v9, v8
  v_mov_b32 v9, 133124
  ds_write_b32 v9, v8
  s_cmp_eq_u32 s38, 0
  s_cselect_b32 s3, 0, 4
  s_add_u32 s3, s3, 133124
  v_mov_b32 v237, s3
  v_mul_u32_u24 v7, 528, v5
  v_bfe_u32 v8, v1, 2, 1
  v_mul_u32_u24 v8, 2112, v8
  v_add3_u32 v7, v7, v8, v6
  v_bfe_u32 v8, v1, 3, 1
  v_lshl_add_u32 v7, v8, 8, v7
  s_add_u32 s3, s79, 65536
  v_add_u32 v206, s3, v7
  s_lshr_b32 s77, s38, 1
  s_mul_i32 s78, s77, 528
  s_and_b32 s3, s38, 1
  s_lshl_b32 s3, s3, 8
  s_add_u32 s78, s78, s3
  s_add_u32 s78, s78, 65536
  v_lshl_add_u32 v207, v1, 2, s78
  v_add_u32 v238, 2112, v207
  s_lshl_b32 s78, s38, 3
  s_add_u32 s78, s78, 0x20600
  v_lshl_add_u32 v208, v1, 6, s78
  s_lshl_b32 s78, s77, 6
  s_add_u32 s78, s78, 0x20600
  v_and_b32 v7, 7, v1
  v_lshl_add_u32 v209, v7, 3, s78
  s_lshl_b32 s78, s36, 16
  s_lshl_b32 s3, s77, 14
  s_add_u32 s78, s78, s3
  s_lshl_b32 s3, s37, 10
  s_add_u32 s78, s78, s3
  s_add_u32 s78, s78, 0x80000
  v_lshl_add_u32 v232, v1, 7, s78
  v_add_u32 v232, 112, v232
  v_lshl_add_u32 v236, v1, 4, s78
  s_and_b32 s3, s38, 1
  s_lshl_b32 s3, s3, 6
  v_add_u32 v7, s3, v1
  v_mul_u32_u24 v8, 147, v7
  v_lshrrev_b32 v8, 12, v8
  v_lshl_add_u32 v7, v8, 2, v7
  v_lshl_add_u32 v210, v7, 2, s78
  v_lshlrev_b32 v7, 1, v2
  v_xor_b32 v7, v7, v3
  v_lshlrev_b32 v7, 4, v7
  v_lshl_add_u32 v217, v2, 10, v7
  v_xor_b32 v218, 128, v217
  v_lshl_add_u32 v7, v2, 3, v4
  v_lshlrev_b32 v7, 8, v7
  v_and_b32 v8, 1, v2
  v_lshl_or_b32 v8, v8, 2, v4
  s_lshl_b32 s3, s38, 1
  s_and_b32 s3, s3, 7
  v_xor_b32 v8, s3, v8
  v_lshl_add_u32 v7, v8, 5, v7
  v_lshl_add_u32 v213, v5, 3, v7
  v_xor_b32 v234, 32, v213
  v_add_u32 v7, 132864, v6
  v_mov_b32 v8, 132352
  v_cmp_eq_u32 vcc, 0, v3
  s_nop 1
  v_cndmask_b32 v215, v8, v7, vcc
  v_cmp_eq_u32 vcc, 1, v3
  s_nop 1
  v_cndmask_b32 v235, v8, v7, vcc
  s_lshl_b32 s78, s75, 14
  s_lshl_b32 s3, s38, 12
  s_add_u32 s78, s78, s3
  s_lshl_b32 s3, s36, 9
  s_add_u32 s78, s78, s3
  s_lshl_b32 s3, s74, 7
  s_add_u32 s78, s78, s3
  s_add_u32 s78, s78, 0x20000
  v_lshl_add_u32 v7, v3, 6, v6
  v_add_u32 v216, s78, v7
  v_and_b32 v7, 7, v1
  v_lshl_add_u32 v7, v7, 2, v2
  s_lshl_b32 s3, s37, 6
  v_lshl_add_u32 v224, v7, 1, s3
  s_cmp_lg_u32 s38, 0
  s_cbranch_scc1 L_nx_20
  global_load_ushort v233, v224, s[8:9]
L_nx_20:
  s_lshr_b32 s78, s37, 1
  s_lshl_b32 s78, s78, 10
  s_and_b32 s3, s37, 1
  s_lshl_b32 s3, s3, 8
  s_add_u32 s78, s78, s3
  s_add_u32 s78, s78, 425984
  v_lshl_add_u32 v225, v7, 3, s78
  v_add_u32 v226, 24576, v225
  s_lshl_b32 s78, s37, 12
  s_add_u32 s78, s78, 0x20000
  v_lshl_add_u32 v227, v1, 4, s78
  s_lshl_b32 s78, s36, 11
  s_lshl_b32 s3, s37, 7
  s_add_u32 s78, s78, s3
  s_add_u32 s78, s78, 0xe000
  v_lshl_add_u32 v228, v7, 2, s78
  s_lshl_b32 s78, s37, 13
  s_add_u32 s78, s78, 0x40000
  v_lshl_add_u32 v229, v1, 4, s78
  v_add_u32 v230, 4096, v229
  v_mov_b32 v116, 0
  v_mov_b32 v117, 0
  v_mov_b32 v118, 0
  v_mov_b32 v119, 0
  v_mov_b32 v120, 0
  v_mov_b32 v121, 0
  v_mov_b32 v122, 0
  v_mov_b32 v123, 0
  v_lshlrev_b32 v9, 3, v2
  s_lshl_b32 s76, s36, 19
  s_lshl_b32 s3, s74, 17
  s_add_u32 s76, s76, s3
  s_lshl_b32 s3, s38, 14
  s_add_u32 s76, s76, s3
  s_lshl_b32 s3, s75, 8
  s_add_u32 s76, s76, s3
  s_lshl_b32 s78, s38, 12
  s_mov_b32 s72, 0x3db504f3
  s_mov_b32 s73, 0x3db504f3
  s_mov_b32 s47, 0x3fb8aa3b
  s_waitcnt lgkmcnt(0)
  s_and_b32 s3, s46, 0x7f7f7f7f
  s_add_u32 s3, s3, 0x01010101
  s_and_b32 s39, s46, 0x80808080
  s_xor_b32 s39, s39, s3
  v_mov_b32 v10, s39
  v_and_b32 v13, 3, v1
  v_lshlrev_b32 v13, 3, v13
  v_lshrrev_b32 v11, v13, v10
  v_and_b32 v13, 1, v1
  v_lshlrev_b32 v13, 4, v13
  v_lshrrev_b32 v12, v13, v10
  v_lshrrev_b32 v231, v9, v10
  s_bfe_u32 s52, s39, 0x80000
  s_bfe_u32 s53, s39, 0x80008
  s_bfe_u32 s54, s39, 0x80010
  s_bfe_u32 s55, s39, 0x80018
  v_xor_b32 v2, 0, v201
  v_xor_b32 v3, 32, v201
  v_xor_b32 v4, 64, v201
  v_xor_b32 v5, 96, v201
  v_xor_b32 v6, 128, v201
  v_xor_b32 v7, 160, v201
  v_xor_b32 v8, 192, v201
  v_xor_b32 v9, 224, v201
  s_cmp_lt_u32 s38, 4
  s_cbranch_scc1 L_skipB_21
  s_barrier
L_skipB_21:
  ds_read_b128 v[16:19], v220 offset:0
  ds_read_b128 v[20:23], v221 offset:0
  ds_read_b128 v[24:27], v222 offset:0
  ds_read_b128 v[28:31], v223 offset:0
  ds_read_b128 v[32:35], v220 offset:4096
  ds_read_b128 v[36:39], v221 offset:4096
  ds_read_b128 v[40:43], v222 offset:4096
  ds_read_b128 v[44:47], v223 offset:4096
  s_mov_b32 s45, 0
  s_mov_b64 s[66:67], s[34:35]
L_poll_22:
  s_mov_b64 exec, -1
  global_load_dword v80, v204, s[66:67] offset:0 sc1
  s_add_u32 s45, s45, 1
  s_and_b32 s3, s45, 31
  s_cmp_eq_u32 s3, 31
  s_cselect_b64 s[66:67], s[64:65], s[34:35]
  s_cmp_gt_u32 s45, 400000
  s_cbranch_scc1 L_bail_24
  s_waitcnt vmcnt(0)
  v_cmpx_eq_u32_sdwa vcc, v80, v11 src0_sel:BYTE_0 src1_sel:BYTE_0
  s_cmp_eq_u64 exec, -1
  s_cbranch_scc0 L_poll_22
L_pdone_23:
  ds_write_b16_d16_hi v205, v80
  s_mov_b32 m0, s78
  s_waitcnt lgkmcnt(0)
  s_barrier
  ds_read_b128 v[80:83], v202 offset:0
  ds_read_b128 v[84:87], v202 offset:64
  ds_read_b128 v[88:91], v202 offset:128
  ds_read_b128 v[92:95], v202 offset:192
  buffer_load_dwordx4 v217, s[56:59], s76 offen nt lds
  s_add_u32 m0, m0, 1024
  s_add_u32 s76, s76, 4096
  buffer_load_dwordx4 v217, s[56:59], s76 offen nt lds
  s_add_u32 m0, m0, 1024
  s_add_u32 s76, s76, 4096
  buffer_load_dwordx4 v218, s[56:59], s76 offen nt lds
  s_add_u32 m0, m0, 1024
  s_add_u32 s76, s76, 4096
  buffer_load_dwordx4 v218, s[56:59], s76 offen nt lds
  s_waitcnt lgkmcnt(3)
  v_mfma_f32_16x16x32_bf16 v[112:115], v[16:19], v[80:83], 0
  v_mfma_f32_16x16x32_bf16 v[96:99], v[32:35], v[80:83], 0
  ds_read_b64_tr_b16 v[48:49], v2
  ds_read_b64_tr_b16 v[50:51], v2 offset:4096
  ds_read_b64_tr_b16 v[52:53], v3
  ds_read_b64_tr_b16 v[54:55], v3 offset:4096
  s_waitcnt lgkmcnt(6)
  v_mfma_f32_16x16x32_bf16 v[112:115], v[20:23], v[84:87], v[112:115]
  v_mfma_f32_16x16x32_bf16 v[96:99], v[36:39], v[84:87], v[96:99]
  ds_read_b64_tr_b16 v[56:57], v4
  ds_read_b64_tr_b16 v[58:59], v4 offset:4096
  ds_read_b64_tr_b16 v[60:61], v5
  ds_read_b64_tr_b16 v[62:63], v5 offset:4096
  s_waitcnt lgkmcnt(9)
  v_mfma_f32_16x16x32_bf16 v[112:115], v[24:27], v[88:91], v[112:115]
  v_mfma_f32_16x16x32_bf16 v[96:99], v[40:43], v[88:91], v[96:99]
  ds_read_b64_tr_b16 v[64:65], v6
  ds_read_b64_tr_b16 v[66:67], v6 offset:4096
  ds_read_b64_tr_b16 v[68:69], v7
  ds_read_b64_tr_b16 v[70:71], v7 offset:4096
  s_waitcnt lgkmcnt(12)
  v_mfma_f32_16x16x32_bf16 v[112:115], v[28:31], v[92:95], v[112:115]
  v_mfma_f32_16x16x32_bf16 v[96:99], v[44:47], v[92:95], v[96:99]
  ds_read_b64_tr_b16 v[72:73], v8
  ds_read_b64_tr_b16 v[74:75], v8 offset:4096
  ds_read_b64_tr_b16 v[76:77], v9
  ds_read_b64_tr_b16 v[78:79], v9 offset:4096
  s_nop 2
  v_cvt_pk_bf16_f32 v136, v112, v113
  v_cvt_pk_bf16_f32 v137, v114, v115
  v_cvt_pk_bf16_f32 v138, v96, v97
  v_cvt_pk_bf16_f32 v139, v98, v99
  v_cndmask_b32 v136, v138, v136, s[4:5]
  v_cndmask_b32 v137, v139, v137, s[4:5]
  v_lshlrev_b32 v112, 16, v136
  v_and_b32 v113, s44, v136
  v_lshlrev_b32 v114, 16, v137
  v_and_b32 v115, s44, v137
  v_pk_mul_f32 v[112:113], v[112:113], s[72:73]
  v_pk_mul_f32 v[114:115], v[114:115], s[72:73]
  v_cvt_pk_bf16_f32 v136, v112, v113
  v_cvt_pk_bf16_f32 v137, v114, v115
  v_lshlrev_b32 v112, 16, v136
  v_and_b32 v113, s44, v136
  v_lshlrev_b32 v114, 16, v137
  v_and_b32 v115, s44, v137
  v_max3_f32 v140, v112, v113, v114
  v_max_f32 v140, v140, v115
  s_nop 1
  v_max_f32_dpp v140, v140, v140 row_ror:8 row_mask:0xf bank_mask:0xf
  v_mov_b32 v136, v140
  s_nop 1
  v_permlane16_swap_b32 v140, v136
  v_max_f32 v140, v140, v136
  v_mov_b32 v136, v140
  s_nop 1
  v_permlane32_swap_b32 v140, v136
  v_max_f32 v140, v140, v136
  v_mul_f32 v136, s47, v140
  v_fma_f32 v112, v112, s47, -v136
  v_fma_f32 v113, v113, s47, -v136
  v_fma_f32 v114, v114, s47, -v136
  v_fma_f32 v115, v115, s47, -v136
  v_exp_f32 v112, v112
  v_exp_f32 v113, v113
  v_exp_f32 v114, v114
  v_exp_f32 v115, v115
  v_and_b32 v144, s44, v112
  v_and_b32 v145, s44, v113
  v_and_b32 v146, s44, v114
  v_and_b32 v147, s44, v115
  v_sub_f32 v148, v112, v144
  v_sub_f32 v149, v113, v145
  v_sub_f32 v150, v114, v146
  v_sub_f32 v151, v115, v147
  v_cndmask_b32 v144, v144, v148, s[6:7]
  v_cndmask_b32 v145, v145, v149, s[6:7]
  v_cndmask_b32 v146, v146, v150, s[6:7]
  v_cndmask_b32 v147, v147, v151, s[6:7]
  v_cvt_pk_bf16_f32 v144, v144, v145
  v_cvt_pk_bf16_f32 v145, v146, v147
  v_add_f32 v141, v112, v113
  v_add_f32 v136, v114, v115
  v_mov_b32_dpp v116, v144 quad_perm:[0,1,2,3] row_mask:0xf bank_mask:0x3
  v_mov_b32_dpp v118, v144 row_ror:8 row_mask:0xf bank_mask:0x3
  v_mov_b32_dpp v117, v145 quad_perm:[0,1,2,3] row_mask:0xf bank_mask:0x3
  v_mov_b32_dpp v119, v145 row_ror:8 row_mask:0xf bank_mask:0x3
  v_mov_b32_dpp v120, v144 row_ror:8 row_mask:0xf bank_mask:0xc
  v_mov_b32_dpp v122, v144 quad_perm:[0,1,2,3] row_mask:0xf bank_mask:0xc
  v_mov_b32_dpp v121, v145 row_ror:8 row_mask:0xf bank_mask:0xc
  v_mov_b32_dpp v123, v145 quad_perm:[0,1,2,3] row_mask:0xf bank_mask:0xc
  v_add_f32 v141, v141, v136
  s_waitcnt lgkmcnt(0)
  v_mfma_f32_16x16x32_bf16 v[16:19], v[48:51], v[116:119], 0
  v_mfma_f32_16x16x32_bf16 v[20:23], v[52:55], v[116:119], 0
  v_add_f32_dpp v141, v141, v141 row_ror:8 row_mask:0xf bank_mask:0xf
  v_mfma_f32_16x16x32_bf16 v[24:27], v[56:59], v[116:119], 0
  v_mfma_f32_16x16x32_bf16 v[28:31], v[60:63], v[116:119], 0
  v_mfma_f32_16x16x32_bf16 v[16:19], v[64:67], v[120:123], v[16:19]
  v_mov_b32 v136, v141
  s_nop 1
  v_permlane16_swap_b32 v141, v136
  v_add_f32 v141, v141, v136
  v_mov_b32 v136, v141
  s_nop 1
  v_permlane32_swap_b32 v141, v136
  v_add_f32 v141, v141, v136
  v_mfma_f32_16x16x32_bf16 v[20:23], v[68:71], v[120:123], v[20:23]
  v_mfma_f32_16x16x32_bf16 v[24:27], v[72:75], v[120:123], v[24:27]
  v_mfma_f32_16x16x32_bf16 v[28:31], v[76:79], v[120:123], v[28:31]
  s_mov_b64 exec, 15
  ds_write_b64 v208, v[140:141]
  s_mov_b64 exec, -1
  ds_write_b128 v206, v[16:19] offset:0
  s_nop 1
  ds_write_b128 v206, v[20:23] offset:64
  ds_write_b128 v206, v[24:27] offset:128
  ds_write_b128 v206, v[28:31] offset:192
  s_mov_b64 exec, -1
  s_waitcnt lgkmcnt(0)
  s_barrier
  ds_read_b64 v[140:141], v209
  ds_read2st64_b32 v[64:65], v207 offset0:0 offset1:32
  ds_read2st64_b32 v[72:73], v238 offset0:0 offset1:32
  ds_read2st64_b32 v[66:67], v207 offset0:64 offset1:96
  ds_read2st64_b32 v[74:75], v238 offset0:64 offset1:96
  ds_read2st64_b32 v[68:69], v207 offset0:128 offset1:160
  ds_read2st64_b32 v[76:77], v238 offset0:128 offset1:160
  ds_read2st64_b32 v[70:71], v207 offset0:192 offset1:224
  ds_read2st64_b32 v[78:79], v238 offset0:192 offset1:224
  s_waitcnt lgkmcnt(8)
  v_mov_b32 v142, v140
  s_nop 1
  v_max_f32_dpp v142, v142, v142 quad_perm:[1,0,3,2] row_mask:0xf bank_mask:0xf
  s_nop 1
  v_max_f32_dpp v142, v142, v142 quad_perm:[2,3,0,1] row_mask:0xf bank_mask:0xf
  s_nop 1
  v_max_f32_dpp v142, v142, v142 row_half_mirror row_mask:0xf bank_mask:0xf
  v_sub_f32 v140, v140, v142
  v_mul_f32 v140, s47, v140
  v_exp_f32 v140, v140
  s_nop 0
  v_mul_f32 v143, v140, v141
  s_waitcnt lgkmcnt(4)
  v_pk_add_f32 v[64:65], v[64:65], v[72:73]
  v_pk_add_f32 v[66:67], v[66:67], v[74:75]
  v_add_f32_dpp v143, v143, v143 quad_perm:[1,0,3,2] row_mask:0xf bank_mask:0xf
  s_waitcnt lgkmcnt(0)
  v_pk_add_f32 v[68:69], v[68:69], v[76:77]
  v_pk_add_f32 v[70:71], v[70:71], v[78:79]
  v_add_f32_dpp v143, v143, v143 quad_perm:[2,3,0,1] row_mask:0xf bank_mask:0xf
  v_mul_f32_dpp v144, v140, v64 row_newbcast:0 row_mask:0xf bank_mask:0xf
  v_mul_f32_dpp v145, v140, v65 row_newbcast:1 row_mask:0xf bank_mask:0xf
  v_mul_f32_dpp v146, v140, v66 row_newbcast:2 row_mask:0xf bank_mask:0xf
  v_mul_f32_dpp v147, v140, v67 row_newbcast:3 row_mask:0xf bank_mask:0xf
  v_add_f32_dpp v143, v143, v143 row_half_mirror row_mask:0xf bank_mask:0xf
  v_fmac_f32_dpp v144, v140, v68 row_newbcast:4 row_mask:0xf bank_mask:0xf
  v_fmac_f32_dpp v145, v140, v69 row_newbcast:5 row_mask:0xf bank_mask:0xf
  v_fmac_f32_dpp v146, v140, v70 row_newbcast:6 row_mask:0xf bank_mask:0xf
  v_fmac_f32_dpp v147, v140, v71 row_newbcast:7 row_mask:0xf bank_mask:0xf
  v_add_f32 v144, v144, v145
  v_add_f32 v146, v146, v147
  v_add_f32 v144, v144, v146
  v_perm_b32 v144, v144, v11, s40
  global_store_dword v210, v144, s[34:35]
  v_perm_b32 v148, v142, v10, s40
  v_perm_b32 v149, v143, v10, s41
  v_perm_b32 v150, v142, v10, s42
  v_perm_b32 v151, v143, v10, s43
  s_mov_b64 exec, 0x1f
  global_store_dwordx4 v232, v[148:151], s[34:35]
  s_mov_b64 exec, -1
  s_waitcnt vmcnt(2)
  s_barrier
  s_cmp_ge_u32 s38, 4
  s_cbranch_scc1 L_skipWF_25
  ds_read_b64_tr_b16 v[160:161], v213 offset:0
  ds_read_b64_tr_b16 v[162:163], v213 offset:1024
  ds_read_b64_tr_b16 v[164:165], v213 offset:8192
  ds_read_b64_tr_b16 v[166:167], v213 offset:9216
  ds_read_b64_tr_b16 v[168:169], v213 offset:16384
  ds_read_b64_tr_b16 v[170:171], v213 offset:17408
  ds_read_b64_tr_b16 v[172:173], v213 offset:24576
  ds_read_b64_tr_b16 v[174:175], v213 offset:25600
  ds_read_b64_tr_b16 v[176:177], v234 offset:0
  ds_read_b64_tr_b16 v[178:179], v234 offset:1024
  ds_read_b64_tr_b16 v[180:181], v234 offset:8192
  ds_read_b64_tr_b16 v[182:183], v234 offset:9216
  ds_read_b64_tr_b16 v[184:185], v234 offset:16384
  ds_read_b64_tr_b16 v[186:187], v234 offset:17408
  ds_read_b64_tr_b16 v[188:189], v234 offset:24576
  ds_read_b64_tr_b16 v[190:191], v234 offset:25600
L_skipWF_25:
  s_cmp_lt_u32 s38, 5
  s_cbranch_scc1 L_doG_27
  s_mov_b32 s79, 0
  v_mov_b32 v48, 133124
  s_nop 1
L_fw_28:
  ds_read_b32 v49, v48
  s_add_u32 s79, s79, 1
  s_cmp_gt_u32 s79, 40
  s_cbranch_scc1 L_fg_29
  s_waitcnt lgkmcnt(0)
  v_readfirstlane_b32 s3, v49
  s_cmp_eq_u32 s3, 0
  s_nop 2
  s_cbranch_scc1 L_fw_28
L_fg_29:
  global_store_dword v210, v144, s[64:65] sc1
  s_mov_b64 exec, 0x1f
  global_store_dwordx4 v232, v[148:151], s[64:65] sc1
  s_mov_b64 exec, -1
  s_mov_b32 s79, 24
  s_branch L_skipG_26
L_doG_27:
  s_mov_b32 s45, 0
  s_mov_b64 s[66:67], s[34:35]
L_poll_30:
  s_mov_b64 exec, -1
  global_load_dwordx4 v[48:51], v211, s[66:67] offset:0 sc1
  global_load_dwordx4 v[52:55], v212, s[66:67] offset:0 sc1
  s_add_u32 s45, s45, 1
  s_and_b32 s3, s45, 31
  s_cmp_eq_u32 s3, 31
  s_cselect_b64 s[66:67], s[64:65], s[34:35]
  s_cmp_lg_u32 s45, 24
  s_cbranch_scc1 L_nd_32
  global_store_dword v210, v144, s[64:65] sc1
  s_mov_b64 exec, 0x1f
  global_store_dwordx4 v232, v[148:151], s[64:65] sc1
  s_mov_b64 exec, -1
  s_nop 0
L_nd_32:
  s_cmp_gt_u32 s45, 400000
  s_cbranch_scc1 L_bail_33
  s_waitcnt vmcnt(0)
  v_xor_b32 v48, s52, v48
  v_xor_b32 v49, s53, v49
  v_xor_b32 v50, s54, v50
  v_xor_b32 v51, s55, v51
  v_xor_b32 v52, s52, v52
  v_xor_b32 v53, s53, v53
  v_xor_b32 v54, s54, v54
  v_xor_b32 v55, s55, v55
  v_or3_b32 v13, v48, v49, v50
  v_or3_b32 v13, v13, v51, v52
  v_or3_b32 v13, v13, v53, v54
  v_or_b32 v13, v13, v55
  v_and_b32 v13, 0xff, v13
  v_cmpx_eq_u32 vcc, 0, v13
  s_cmp_eq_u64 exec, -1
  s_cbranch_scc0 L_poll_30
L_pdone_31:
  s_mov_b32 s79, s45
  ds_write_b32 v237, v237
  v_max_f32 v58, v48, v52
  s_nop 1
  v_max_f32_dpp v58, v58, v58 row_ror:8 row_mask:0xf bank_mask:0xf
  v_mov_b32 v59, v58
  s_nop 1
  v_permlane16_swap_b32 v58, v59
  v_max_f32 v58, v58, v59
  v_mov_b32 v59, v58
  s_nop 1
  v_permlane32_swap_b32 v58, v59
  v_max_f32 v58, v58, v59
  v_sub_f32 v56, v48, v58
  v_sub_f32 v57, v52, v58
  v_mul_f32 v56, s47, v56
  v_mul_f32 v57, s47, v57
  v_exp_f32 v56, v56
  v_exp_f32 v57, v57
  s_nop 0
  v_mul_f32 v58, v56, v49
  v_mov_b32_dpp v60, v56 row_newbcast:7 row_mask:0xf bank_mask:0x3
  v_mov_b32_dpp v61, v57 row_newbcast:7 row_mask:0xf bank_mask:0x3
  v_fmac_f32 v58, v57, v53
  v_mov_b32_dpp v60, v56 row_newbcast:15 row_mask:0xf bank_mask:0xc
  v_mov_b32_dpp v61, v57 row_newbcast:15 row_mask:0xf bank_mask:0xc
  v_add_f32_dpp v58, v58, v58 row_ror:8 row_mask:0xf bank_mask:0xf
  v_mul_f32 v48, v60, v48
  v_mul_f32 v49, v60, v49
  v_mul_f32 v50, v60, v50
  v_mul_f32 v51, v60, v51
  v_fmac_f32 v48, v61, v52
  v_fmac_f32 v49, v61, v53
  v_fmac_f32 v50, v61, v54
  v_fmac_f32 v51, v61, v55
  v_mov_b32 v59, v58
  s_nop 1
  v_permlane16_swap_b32 v58, v59
  v_add_f32 v58, v58, v59
  v_mov_b32 v59, v58
  s_nop 1
  v_permlane32_swap_b32 v58, v59
  v_add_f32 v58, v58, v59
  v_permlane32_swap_b32 v48, v50
  v_permlane32_swap_b32 v49, v51
  v_add_f32 v48, v48, v50
  v_add_f32 v49, v49, v51
  s_nop 1
  v_permlane16_swap_b32 v48, v49
  v_add_f32 v48, v48, v49
  v_rcp_f32 v58, v58
  s_nop 0
  v_add_f32_dpp v48, v48, v48 row_ror:8 row_mask:0xf bank_mask:0xf
  s_nop 1
  v_mul_f32_dpp v48, v58, v48 row_newbcast:7 row_mask:0xf bank_mask:0xf
  v_cvt_pk_bf16_f32 v48, v48, v48
  ds_write_b16 v214, v48
  s_nop 0
L_skipG_26:
  s_waitcnt lgkmcnt(0)
  s_barrier
  s_cmp_ge_u32 s38, 4
  s_cbranch_scc1 L_skipD_34
  ds_read_b128 v[64:67], v215 offset:0
  ds_read_b128 v[68:71], v215 offset:64
  ds_read_b128 v[72:75], v215 offset:128
  ds_read_b128 v[76:79], v215 offset:192
  ds_read_b128 v[80:83], v235 offset:0
  ds_read_b128 v[84:87], v235 offset:64
  ds_read_b128 v[88:91], v235 offset:128
  ds_read_b128 v[92:95], v235 offset:192
  s_waitcnt lgkmcnt(7)
  v_mfma_f32_16x16x32_bf16 v[48:51], v[160:163], v[64:67], 0
  s_waitcnt lgkmcnt(6)
  v_mfma_f32_16x16x32_bf16 v[48:51], v[164:167], v[68:71], v[48:51]
  s_waitcnt lgkmcnt(5)
  v_mfma_f32_16x16x32_bf16 v[48:51], v[168:171], v[72:75], v[48:51]
  s_waitcnt lgkmcnt(4)
  v_mfma_f32_16x16x32_bf16 v[48:51], v[172:175], v[76:79], v[48:51]
  s_waitcnt lgkmcnt(3)
  v_mfma_f32_16x16x32_bf16 v[48:51], v[176:179], v[80:83], v[48:51]
  s_waitcnt lgkmcnt(2)
  v_mfma_f32_16x16x32_bf16 v[48:51], v[180:183], v[84:87], v[48:51]
  s_waitcnt lgkmcnt(1)
  v_mfma_f32_16x16x32_bf16 v[48:51], v[184:187], v[88:91], v[48:51]
  s_waitcnt lgkmcnt(0)
  v_mfma_f32_16x16x32_bf16 v[48:51], v[188:191], v[92:95], v[48:51]
  s_nop 7
  v_perm_b32 v52, v48, v10, s40
  v_perm_b32 v53, v49, v10, s41
  v_perm_b32 v54, v50, v10, s42
  v_perm_b32 v55, v51, v10, s43
  s_mov_b32 exec_lo, 0x00030003
  s_mov_b32 exec_hi, 0x00030003
  global_store_dwordx4 v216, v[52:55], s[34:35] sc1
  s_mov_b64 exec, -1
  s_nop 0
L_skipD_34:
  s_cmp_ge_u32 s79, 24
  s_cbranch_scc1 L_nd_35
  global_store_dword v210, v144, s[64:65] sc1
  s_mov_b64 exec, 0x1f
  global_store_dwordx4 v232, v[148:151], s[64:65] sc1
  s_mov_b64 exec, -1
  s_nop 0
L_nd_35:
  s_cmp_lg_u32 s38, 0
  s_cbranch_scc1 L_exit
  s_waitcnt vmcnt(0)
  s_mov_b32 s45, 0
L_poll_36:
  s_mov_b64 exec, -1
  global_load_dwordx4 v[32:35], v227, s[34:35] offset:0 sc1
  global_load_dwordx4 v[36:39], v227, s[34:35] offset:1024 sc1
  global_load_dwordx4 v[40:43], v227, s[34:35] offset:2048 sc1
  global_load_dwordx4 v[44:47], v227, s[34:35] offset:3072 sc1
  global_load_dwordx2 v[24:25], v225, s[34:35] offset:0 sc1
  global_load_dwordx2 v[26:27], v225, s[34:35] offset:512 sc1
  global_load_dwordx2 v[28:29], v226, s[34:35] offset:0 sc1
  global_load_dwordx2 v[30:31], v226, s[34:35] offset:512 sc1
  s_add_u32 s45, s45, 1
  s_cmp_gt_u32 s45, 400000
  s_cbranch_scc1 L_bail_38
  s_waitcnt vmcnt(0)
  v_xor_b32 v32, s52, v32
  v_xor_b32 v33, s53, v33
  v_xor_b32 v34, s54, v34
  v_xor_b32 v35, s55, v35
  v_xor_b32 v36, s52, v36
  v_xor_b32 v37, s53, v37
  v_xor_b32 v38, s54, v38
  v_xor_b32 v39, s55, v39
  v_xor_b32 v40, s52, v40
  v_xor_b32 v41, s53, v41
  v_xor_b32 v42, s54, v42
  v_xor_b32 v43, s55, v43
  v_xor_b32 v44, s52, v44
  v_xor_b32 v45, s53, v45
  v_xor_b32 v46, s54, v46
  v_xor_b32 v47, s55, v47
  v_or3_b32 v13, v32, v33, v34
  v_or3_b32 v13, v13, v35, v36
  v_or3_b32 v13, v13, v37, v38
  v_or3_b32 v13, v13, v39, v40
  v_or3_b32 v13, v13, v41, v42
  v_or3_b32 v13, v13, v43, v44
  v_or3_b32 v13, v13, v45, v46
  v_or_b32 v13, v13, v47
  v_and_b32 v13, 0xff, v13
  v_cmpx_eq_u32 vcc, 0, v13
  v_cmpx_eq_u32 vcc, v25, v10
  v_cmpx_eq_u32 vcc, v27, v10
  v_cmpx_eq_u32 vcc, v29, v10
  v_cmpx_eq_u32 vcc, v31, v10
  s_cmp_eq_u64 exec, -1
  s_cbranch_scc0 L_poll_36
L_pdone_37:
  v_add_f32 v21, v24, v26
  v_add_f32 v23, v28, v30
  v_cvt_pk_bf16_f32 v22, v21, v23
  v_lshlrev_b32 v21, 16, v22
  v_and_b32 v23, s44, v22
  v_lshlrev_b32 v20, 16, v233
  v_pk_add_f32 v[32:33], v[32:33], v[36:37]
  v_pk_add_f32 v[40:41], v[40:41], v[44:45]
  v_pk_add_f32 v[34:35], v[34:35], v[38:39]
  v_pk_add_f32 v[42:43], v[42:43], v[46:47]
  v_pk_add_f32 v[32:33], v[32:33], v[40:41]
  v_pk_add_f32 v[34:35], v[34:35], v[42:43]
  s_nop 1
  v_permlane32_swap_b32 v32, v34
  v_permlane32_swap_b32 v33, v35
  v_add_f32 v32, v32, v34
  v_add_f32 v33, v33, v35
  s_nop 1
  v_permlane16_swap_b32 v32, v33
  v_add_f32 v32, v32, v33
  s_nop 1
  v_add_f32_dpp v32, v32, v32 row_ror:8 row_mask:0xf bank_mask:0xf
  v_cvt_pk_bf16_f32 v32, v32, v32
  v_and_b32 v32, s44, v32
  v_mul_f32 v32, v32, v21
  v_cvt_pk_bf16_f32 v32, v32, v32
  v_and_b32 v32, s44, v32
  v_add_f32 v32, v32, v20
  v_cvt_pk_bf16_f32 v32, v32, v32
  v_perm_b32 v33, v32, v231, s40
  s_mov_b32 exec_lo, 0x00ff00ff
  s_mov_b32 exec_hi, 0x00ff00ff
  global_store_dword v228, v33, s[34:35]
  global_store_dword v228, v33, s[64:65] sc1
  s_mov_b64 exec, -1
  v_and_b32 v20, s44, v32
  s_and_b32 s77, s37, 7
  s_cmp_lg_u32 s77, s36
  s_cbranch_scc1 L_notF_39
  s_mov_b32 s45, 0
L_poll_40:
  s_mov_b64 exec, -1
  global_load_dwordx4 v[32:35], v229, s[34:35] offset:0 sc1
  global_load_dwordx4 v[36:39], v229, s[34:35] offset:1024 sc1
  global_load_dwordx4 v[40:43], v229, s[34:35] offset:2048 sc1
  global_load_dwordx4 v[44:47], v229, s[34:35] offset:3072 sc1
  global_load_dwordx4 v[48:51], v230, s[34:35] offset:0 sc1
  global_load_dwordx4 v[52:55], v230, s[34:35] offset:1024 sc1
  global_load_dwordx4 v[56:59], v230, s[34:35] offset:2048 sc1
  s_add_u32 s45, s45, 1
  s_cmp_gt_u32 s45, 400000
  s_cbranch_scc1 L_bail_42
  s_waitcnt vmcnt(0)
  v_xor_b32 v32, s52, v32
  v_xor_b32 v33, s53, v33
  v_xor_b32 v34, s54, v34
  v_xor_b32 v35, s55, v35
  v_xor_b32 v36, s52, v36
  v_xor_b32 v37, s53, v37
  v_xor_b32 v38, s54, v38
  v_xor_b32 v39, s55, v39
  v_xor_b32 v40, s52, v40
  v_xor_b32 v41, s53, v41
  v_xor_b32 v42, s54, v42
  v_xor_b32 v43, s55, v43
  v_xor_b32 v44, s52, v44
  v_xor_b32 v45, s53, v45
  v_xor_b32 v46, s54, v46
  v_xor_b32 v47, s55, v47
  v_xor_b32 v48, s52, v48
  v_xor_b32 v49, s53, v49
  v_xor_b32 v50, s54, v50
  v_xor_b32 v51, s55, v51
  v_xor_b32 v52, s52, v52
  v_xor_b32 v53, s53, v53
  v_xor_b32 v54, s54, v54
  v_xor_b32 v55, s55, v55
  v_xor_b32 v56, s52, v56
  v_xor_b32 v57, s53, v57
  v_xor_b32 v58, s54, v58
  v_xor_b32 v59, s55, v59
  v_or3_b32 v13, v32, v33, v34
  v_or3_b32 v13, v13, v35, v36
  v_or3_b32 v13, v13, v37, v38
  v_or3_b32 v13, v13, v39, v40
  v_or3_b32 v13, v13, v41, v42
  v_or3_b32 v13, v13, v43, v44
  v_or3_b32 v13, v13, v45, v46
  v_or3_b32 v13, v13, v47, v48
  v_or3_b32 v13, v13, v49, v50
  v_or3_b32 v13, v13, v51, v52
  v_or3_b32 v13, v13, v53, v54
  v_or3_b32 v13, v13, v55, v56
  v_or3_b32 v13, v13, v57, v58
  v_or_b32 v13, v13, v59
  v_and_b32 v13, 0xff, v13
  v_cmpx_eq_u32 vcc, 0, v13
  s_cmp_eq_u64 exec, -1
  s_cbranch_scc0 L_poll_40
L_pdone_41:
  v_pk_add_f32 v[32:33], v[32:33], v[36:37]
  v_pk_add_f32 v[40:41], v[40:41], v[44:45]
  v_pk_add_f32 v[48:49], v[48:49], v[52:53]
  v_pk_add_f32 v[34:35], v[34:35], v[38:39]
  v_pk_add_f32 v[42:43], v[42:43], v[46:47]
  v_pk_add_f32 v[50:51], v[50:51], v[54:55]
  v_pk_add_f32 v[32:33], v[32:33], v[56:57]
  v_pk_add_f32 v[40:41], v[40:41], v[48:49]
  v_pk_add_f32 v[34:35], v[34:35], v[58:59]
  v_pk_add_f32 v[42:43], v[42:43], v[50:51]
  v_pk_add_f32 v[32:33], v[32:33], v[40:41]
  v_pk_add_f32 v[34:35], v[34:35], v[42:43]
  s_nop 1
  v_permlane32_swap_b32 v32, v34
  v_permlane32_swap_b32 v33, v35
  v_add_f32 v32, v32, v34
  v_add_f32 v33, v33, v35
  s_nop 1
  v_permlane16_swap_b32 v32, v33
  v_add_f32 v32, v32, v33
  s_nop 1
  v_add_f32_dpp v32, v32, v32 row_ror:8 row_mask:0xf bank_mask:0xf
  v_cvt_pk_bf16_f32 v32, v32, v32
  v_and_b32 v32, s44, v32
  v_mul_f32 v32, v32, v23
  v_cvt_pk_bf16_f32 v32, v32, v32
  v_and_b32 v32, s44, v32
  v_add_f32 v32, v32, v20
  v_cvt_pk_bf16_f32 v32, v32, v32
  s_mov_b32 exec_lo, 0x00ff00ff
  s_mov_b32 exec_hi, 0x00ff00ff
  global_store_short v224, v32, s[30:31]
  s_mov_b64 exec, -1
  s_cmp_lg_u32 s2, 0
  s_cbranch_scc1 L_notF_39
  v_mov_b32 v2, 0
  s_mov_b64 exec, 1
  global_store_dword v2, v10, s[34:35] sc1
  s_mov_b64 exec, -1
L_notF_39:
  s_endpgm
L_M:
  s_cmp_lg_u32 s38, 5
  s_cbranch_scc1 L_skipP_43
  v_lshrrev_b32 v2, 3, v1
  v_and_b32 v3, 7, v1
  v_lshl_add_u32 v2, v2, 6, v3
  v_lshlrev_b32 v2, 13, v2
  s_lshl_b32 s77, s74, 16
  s_lshl_b32 s3, s36, 10
  s_add_u32 s77, s77, s3
  s_add_u32 s77, s77, 0x10180
  v_add_u32 v2, s77, v2
  global_load_dword v31, v2, s[14:15] nt
  s_nop 0
L_skipP_43:
  s_mul_i32 s76, s36, 7
  s_add_u32 s76, s76, s74
  s_mov_b32 s52, s20
  s_mov_b32 s53, s21
  s_mov_b32 s54, 0x1c0000
  s_mov_b32 s55, 0x20000
  s_mov_b32 s56, s22
  s_mov_b32 s57, s23
  s_mov_b32 s58, 0x1c0000
  s_mov_b32 s59, 0x20000
  s_mov_b32 s60, s24
  s_mov_b32 s61, s25
  s_mov_b32 s62, 0x1c0000
  s_mov_b32 s63, 0x20000
  v_lshrrev_b32 v6, 2, v1
  v_mul_u32_u24 v4, 3584, v6
  v_lshrrev_b32 v6, 5, v1
  v_and_b32 v9, 3, v1
  v_xor_b32 v6, v6, v9
  v_lshl_add_u32 v4, v6, 4, v4
  v_xor_b32 v5, 32, v4
  s_bfe_u32 s3, s38, 0x10001
  s_lshl_b32 s3, s3, 7
  v_lshlrev_b32 v6, 4, v1
  v_xor_b32 v6, s3, v6
  v_xor_b32 v14, 0, v6
  v_xor_b32 v15, 32, v6
  v_xor_b32 v16, 64, v6
  v_xor_b32 v17, 96, v6
  v_mov_b32 v2, 0
  v_lshlrev_b32 v3, 2, v1
  v_and_b32 v3, 63, v3
  v_add_u32 v3, 119872, v3
  ds_write_b32 v3, v2
  v_lshrrev_b32 v2, 4, v1
  v_bfe_u32 v3, v1, 2, 2
  v_lshl_add_u32 v9, v2, 3, v3
  v_lshlrev_b32 v7, 6, v9
  v_bfe_u32 v18, v1, 1, 1
  v_lshl_add_u32 v7, v18, 15, v7
  v_and_b32 v19, 1, v2
  v_lshl_or_b32 v19, v18, 1, v19
  v_xor_b32 v19, s79, v19
  v_lshl_add_u32 v7, v19, 4, v7
  v_and_b32 v19, 1, v1
  v_lshl_add_u32 v7, v19, 3, v7
  v_add_u32 v7, 20480, v7
  v_and_b32 v19, 1, v2
  v_lshl_or_b32 v19, v19, 2, v3
  v_lshlrev_b32 v8, 10, v9
  v_lshl_add_u32 v8, v19, 5, v8
  v_and_b32 v19, 3, v1
  v_lshl_add_u32 v8, v19, 3, v8
  s_lshl_b32 s77, s79, 8
  s_add_u32 s77, s77, 0x15000
  v_add_u32 v8, s77, v8
  v_lshrrev_b32 v19, 5, v1
  v_lshlrev_b32 v19, 10, v19
  v_and_b32 v20, 31, v1
  v_lshl_add_u32 v19, v20, 4, v19
  s_lshl_b32 s77, s79, 11
  s_add_u32 s77, s77, 0x6a000
  v_add_u32 v19, s77, v19
  v_add_u32 v20, 8192, v19
  s_lshl_b32 s77, s36, 11
  s_add_u32 s77, s77, 0xe000
  v_lshl_add_u32 v24, v1, 4, s77
  s_lshl_b32 s3, s79, 9
  s_add_u32 s77, s77, s3
  v_lshl_add_u32 v25, v1, 3, s77
  s_lshl_b32 s77, s79, 8
  s_add_u32 s77, s77, 0x1d000
  v_lshl_add_u32 v21, v1, 2, s77
  v_and_b32 v22, 48, v1
  v_add_u32 v22, 118784, v22
  v_bfe_u32 v2, v1, 4, 1
  v_lshlrev_b32 v23, 3, v2
  v_lshrrev_b32 v2, 5, v1
  v_lshl_add_u32 v23, v2, 1, v23
  s_lshl_b32 s77, s79, 4
  s_add_u32 s77, s77, 0x1d400
  v_add_u32 v23, s77, v23
  v_and_b32 v2, 15, v1
  v_and_b32 v3, 48, v1
  v_add_u32 v3, 119808, v3
  v_mov_b32 v9, 119872
  v_cmp_eq_u32 vcc, 0, v2
  s_nop 1
  v_cndmask_b32 v140, v9, v3, vcc
  v_cmp_eq_u32 vcc, 1, v2
  s_nop 1
  v_cndmask_b32 v141, v9, v3, vcc
  v_cmp_eq_u32 vcc, 2, v2
  s_nop 1
  v_cndmask_b32 v142, v9, v3, vcc
  v_cmp_eq_u32 vcc, 3, v2
  s_nop 1
  v_cndmask_b32 v143, v9, v3, vcc
  v_cmp_eq_u32 vcc, 4, v2
  s_nop 1
  v_cndmask_b32 v144, v9, v3, vcc
  v_cmp_eq_u32 vcc, 5, v2
  s_nop 1
  v_cndmask_b32 v145, v9, v3, vcc
  v_cmp_eq_u32 vcc, 6, v2
  s_nop 1
  v_cndmask_b32 v146, v9, v3, vcc
  v_cmp_eq_u32 vcc, 7, v2
  s_nop 1
  v_cndmask_b32 v147, v9, v3, vcc
  v_lshrrev_b32 v9, 1, v2
  v_lshlrev_b32 v9, 13, v9
  v_and_b32 v2, 1, v2
  v_lshl_add_u32 v9, v2, 6, v9
  v_and_b32 v2, 48, v1
  v_add_u32 v9, v9, v2
  s_lshl_b32 s77, s79, 15
  s_lshl_b32 s3, s76, 7
  s_add_u32 s77, s77, s3
  s_add_u32 s77, s77, 0x40000
  v_add_u32 v9, s77, v9
  v_mov_b32 v26, 0x3f803f80
  v_mov_b32 v27, 0x3b000000
  v_mov_b32 v28, 0x3d372713
  s_mov_b32 s47, 0x07060302
  s_mul_i32 s77, s38, 229376
  s_lshl_b32 s3, s76, 6
  s_add_u32 s77, s77, s3
  s_lshl_b32 s78, s38, 12
  s_add_u32 s72, s78, 20480
  s_add_u32 s73, s78, 53248
  s_mov_b32 m0, s72
  s_nop 0
  buffer_load_dwordx4 v4, s[52:55], s77 offen nt lds
  s_mov_b32 m0, s73
  s_nop 0
  buffer_load_dwordx4 v5, s[56:59], s77 offen nt lds
  s_add_u32 s72, s72, 1024
  s_add_u32 s73, s73, 1024
  s_add_u32 s77, s77, 57344
  s_mov_b32 m0, s72
  s_nop 0
  buffer_load_dwordx4 v4, s[52:55], s77 offen nt lds
  s_mov_b32 m0, s73
  s_nop 0
  buffer_load_dwordx4 v5, s[56:59], s77 offen nt lds
  s_add_u32 s72, s72, 1024
  s_add_u32 s73, s73, 1024
  s_add_u32 s77, s77, 57344
  s_mov_b32 m0, s72
  s_nop 0
  buffer_load_dwordx4 v4, s[52:55], s77 offen nt lds
  s_mov_b32 m0, s73
  s_nop 0
  buffer_load_dwordx4 v5, s[56:59], s77 offen nt lds
  s_add_u32 s72, s72, 1024
  s_add_u32 s73, s73, 1024
  s_add_u32 s77, s77, 57344
  s_mov_b32 m0, s72
  s_nop 0
  buffer_load_dwordx4 v4, s[52:55], s77 offen nt lds
  s_mov_b32 m0, s73
  s_nop 0
  buffer_load_dwordx4 v5, s[56:59], s77 offen nt lds
  s_lshl_b32 s77, s76, 15
  s_add_u32 s77, s77, s78
  s_add_u32 s72, s78, 86016
  s_mov_b32 m0, s72
  s_nop 0
  buffer_load_dwordx4 v14, s[60:63], s77 offen nt lds
  s_add_u32 s72, s72, 1024
  s_add_u32 s77, s77, 1024
  s_mov_b32 m0, s72
  s_nop 0
  buffer_load_dwordx4 v15, s[60:63], s77 offen nt lds
  s_add_u32 s72, s72, 1024
  s_add_u32 s77, s77, 1024
  s_mov_b32 m0, s72
  s_nop 0
  buffer_load_dwordx4 v16, s[60:63], s77 offen nt lds
  s_add_u32 s72, s72, 1024
  s_add_u32 s77, s77, 1024
  s_mov_b32 m0, s72
  s_nop 0
  buffer_load_dwordx4 v17, s[60:63], s77 offen nt lds
  s_waitcnt vmcnt(0) lgkmcnt(0)
  s_barrier
  s_cmp_ge_u32 s38, 4
  s_cbranch_scc1 L_exit
  ds_read_b64_tr_b16 v[32:33], v7 offset:0
  ds_read_b64_tr_b16 v[34:35], v7 offset:256
  ds_read_b64_tr_b16 v[36:37], v7 offset:2048
  ds_read_b64_tr_b16 v[38:39], v7 offset:2304
  ds_read_b64_tr_b16 v[40:41], v7 offset:4096
  ds_read_b64_tr_b16 v[42:43], v7 offset:4352
  ds_read_b64_tr_b16 v[44:45], v7 offset:6144
  ds_read_b64_tr_b16 v[46:47], v7 offset:6400
  ds_read_b64_tr_b16 v[48:49], v7 offset:8192
  ds_read_b64_tr_b16 v[50:51], v7 offset:8448
  ds_read_b64_tr_b16 v[52:53], v7 offset:10240
  ds_read_b64_tr_b16 v[54:55], v7 offset:10496
  ds_read_b64_tr_b16 v[56:57], v7 offset:12288
  ds_read_b64_tr_b16 v[58:59], v7 offset:12544
  ds_read_b64_tr_b16 v[60:61], v7 offset:14336
  ds_read_b64_tr_b16 v[62:63], v7 offset:14592
  ds_read_b64_tr_b16 v[64:65], v7 offset:16384
  ds_read_b64_tr_b16 v[66:67], v7 offset:16640
  ds_read_b64_tr_b16 v[68:69], v7 offset:18432
  ds_read_b64_tr_b16 v[70:71], v7 offset:18688
  ds_read_b64_tr_b16 v[72:73], v7 offset:20480
  ds_read_b64_tr_b16 v[74:75], v7 offset:20736
  ds_read_b64_tr_b16 v[76:77], v7 offset:22528
  ds_read_b64_tr_b16 v[78:79], v7 offset:22784
  ds_read_b64_tr_b16 v[80:81], v7 offset:24576
  ds_read_b64_tr_b16 v[82:83], v7 offset:24832
  ds_read_b64_tr_b16 v[84:85], v7 offset:26624
  ds_read_b64_tr_b16 v[86:87], v7 offset:26880
  ds_read_b64_tr_b16 v[88:89], v7 offset:28672
  ds_read_b64_tr_b16 v[90:91], v7 offset:28928
  ds_read_b64_tr_b16 v[92:93], v7 offset:30720
  ds_read_b64_tr_b16 v[94:95], v7 offset:30976
  v_xor_b32 v2, 0, v8
  ds_read_b64_tr_b16 v[96:97], v2
  ds_read_b64_tr_b16 v[98:99], v2 offset:4096
  v_xor_b32 v2, 32, v8
  ds_read_b64_tr_b16 v[100:101], v2
  ds_read_b64_tr_b16 v[102:103], v2 offset:4096
  v_xor_b32 v2, 64, v8
  ds_read_b64_tr_b16 v[104:105], v2
  ds_read_b64_tr_b16 v[106:107], v2 offset:4096
  v_xor_b32 v2, 96, v8
  ds_read_b64_tr_b16 v[108:109], v2
  ds_read_b64_tr_b16 v[110:111], v2 offset:4096
  v_xor_b32 v2, 128, v8
  ds_read_b64_tr_b16 v[112:113], v2
  ds_read_b64_tr_b16 v[114:115], v2 offset:4096
  v_xor_b32 v2, 160, v8
  ds_read_b64_tr_b16 v[116:117], v2
  ds_read_b64_tr_b16 v[118:119], v2 offset:4096
  v_xor_b32 v2, 192, v8
  ds_read_b64_tr_b16 v[120:121], v2
  ds_read_b64_tr_b16 v[122:123], v2 offset:4096
  v_xor_b32 v2, 224, v8
  ds_read_b64_tr_b16 v[124:125], v2
  ds_read_b64_tr_b16 v[126:127], v2 offset:4096
  s_mov_b32 s45, 0
L_poll_44:
  s_mov_b64 exec, -1
  global_load_dwordx4 v[150:153], v19, s[34:35] offset:0 sc1
  global_load_dwordx4 v[154:157], v19, s[34:35] offset:512 sc1
  global_load_dwordx4 v[158:161], v20, s[34:35] offset:0 sc1
  global_load_dwordx4 v[162:165], v20, s[34:35] offset:512 sc1
  s_add_u32 s45, s45, 1
  s_cmp_gt_u32 s45, 400000
  s_cbranch_scc1 L_bail_46
  s_waitcnt vmcnt(0)
  v_cmpx_eq_u32 vcc, v151, v10
  v_cmpx_eq_u32 vcc, v153, v10
  v_cmpx_eq_u32 vcc, v155, v10
  v_cmpx_eq_u32 vcc, v157, v10
  v_cmpx_eq_u32 vcc, v159, v10
  v_cmpx_eq_u32 vcc, v161, v10
  v_cmpx_eq_u32 vcc, v163, v10
  v_cmpx_eq_u32 vcc, v165, v10
  s_cmp_eq_u64 exec, -1
  s_cbranch_scc0 L_poll_44
L_pdone_45:
  v_add_f32 v128, v150, v154
  v_add_f32 v129, v152, v156
  v_add_f32 v132, v158, v162
  v_add_f32 v133, v160, v164
  v_cvt_pk_bf16_f32 v136, v128, v129
  v_lshlrev_b32 v128, 16, v136
  v_and_b32 v129, s44, v136
  v_cvt_pk_bf16_f32 v136, v132, v133
  v_lshlrev_b32 v132, 16, v136
  v_and_b32 v133, s44, v136
  v_add_f32 v132, 1.0, v132
  v_add_f32 v133, 1.0, v133
  v_cvt_pk_bf16_f32 v136, v132, v133
  v_lshlrev_b32 v132, 16, v136
  v_and_b32 v133, s44, v136
  s_waitcnt lgkmcnt(0)
  s_mov_b32 s45, 0
  s_mov_b64 s[66:67], s[34:35]
L_poll_47:
  s_mov_b64 exec, -1
  global_load_dwordx4 v[150:153], v24, s[66:67] offset:0 sc1
  global_load_dwordx4 v[154:157], v24, s[66:67] offset:1024 sc1
  global_load_dwordx2 v[158:159], v25, s[66:67] offset:0 sc1
  s_add_u32 s45, s45, 1
  s_and_b32 s3, s45, 31
  s_cmp_eq_u32 s3, 31
  s_cselect_b64 s[66:67], s[64:65], s[34:35]
  s_cmp_gt_u32 s45, 400000
  s_cbranch_scc1 L_bail_49
  s_waitcnt vmcnt(0)
  v_cmpx_eq_u32_sdwa vcc, v150, v10 src0_sel:BYTE_0 src1_sel:BYTE_0
  v_cmpx_eq_u32_sdwa vcc, v151, v10 src0_sel:BYTE_0 src1_sel:BYTE_1
  v_cmpx_eq_u32_sdwa vcc, v152, v10 src0_sel:BYTE_0 src1_sel:BYTE_2
  v_cmpx_eq_u32_sdwa vcc, v153, v10 src0_sel:BYTE_0 src1_sel:BYTE_3
  v_cmpx_eq_u32_sdwa vcc, v154, v10 src0_sel:BYTE_0 src1_sel:BYTE_0
  v_cmpx_eq_u32_sdwa vcc, v155, v10 src0_sel:BYTE_0 src1_sel:BYTE_1
  v_cmpx_eq_u32_sdwa vcc, v156, v10 src0_sel:BYTE_0 src1_sel:BYTE_2
  v_cmpx_eq_u32_sdwa vcc, v157, v10 src0_sel:BYTE_0 src1_sel:BYTE_3
  v_cmpx_eq_u32_sdwa vcc, v158, v12 src0_sel:BYTE_0 src1_sel:BYTE_0
  v_cmpx_eq_u32_sdwa vcc, v159, v12 src0_sel:BYTE_0 src1_sel:BYTE_1
  s_cmp_eq_u64 exec, -1
  s_cbranch_scc0 L_poll_47
L_pdone_48:
  v_perm_b32 v150, v151, v150, s47
  v_perm_b32 v151, v153, v152, s47
  v_perm_b32 v152, v155, v154, s47
  v_perm_b32 v153, v157, v156, s47
  v_and_b32 v158, s44, v158
  v_and_b32 v159, s44, v159
  v_dot2_f32_bf16 v160, v150, v26, 0
  v_dot2_f32_bf16 v161, v150, v150, 0
  v_dot2_f32_bf16 v160, v151, v26, v160
  v_dot2_f32_bf16 v161, v151, v151, v161
  v_dot2_f32_bf16 v160, v152, v26, v160
  v_dot2_f32_bf16 v161, v152, v152, v161
  v_dot2_f32_bf16 v160, v153, v26, v160
  v_dot2_f32_bf16 v161, v153, v153, v161
  s_nop 2
  v_add_f32_dpp v160, v160, v160 quad_perm:[1,0,3,2] row_mask:0xf bank_mask:0xf
  v_add_f32_dpp v161, v161, v161 quad_perm:[1,0,3,2] row_mask:0xf bank_mask:0xf
  s_nop 0
  v_add_f32_dpp v160, v160, v160 quad_perm:[2,3,0,1] row_mask:0xf bank_mask:0xf
  v_add_f32_dpp v161, v161, v161 quad_perm:[2,3,0,1] row_mask:0xf bank_mask:0xf
  s_nop 0
  v_add_f32_dpp v160, v160, v160 row_half_mirror row_mask:0xf bank_mask:0xf
  v_add_f32_dpp v161, v161, v161 row_half_mirror row_mask:0xf bank_mask:0xf
  s_nop 0
  v_add_f32_dpp v160, v160, v160 row_mirror row_mask:0xf bank_mask:0xf
  v_add_f32_dpp v161, v161, v161 row_mirror row_mask:0xf bank_mask:0xf
  s_nop 1
  v_permlane32_swap_b32 v160, v161
  v_add_f32 v160, v160, v161
  v_mov_b32 v161, v160
  s_nop 1
  v_permlane16_swap_b32 v160, v161
  v_add_f32 v160, v160, v161
  s_nop 0
  v_readlane_b32 s77, v160, 0
  v_readlane_b32 s78, v160, 32
  s_nop 0
  v_mul_f32 v162, s77, v27
  v_mul_f32 v163, s78, v27
  v_fma_f32 v163, -v162, v162, v163
  v_max_f32 v163, 0, v163
  v_cvt_pk_bf16_f32 v164, v162, v163
  v_lshlrev_b32 v162, 16, v164
  v_and_b32 v163, s44, v164
  v_add_f32 v163, 0x3727c5ac, v163
  v_cvt_pk_bf16_f32 v163, v163, v163
  v_and_b32 v163, s44, v163
  v_sqrt_f32 v163, v163
  s_nop 0
  v_cvt_pk_bf16_f32 v163, v163, v163
  v_and_b32 v163, s44, v163
  v_rcp_f32 v163, v163
  v_sub_f32 v158, v158, v162
  v_sub_f32 v159, v159, v162
  v_cvt_pk_bf16_f32 v165, v158, v159
  v_lshlrev_b32 v158, 16, v165
  v_and_b32 v159, s44, v165
  v_mul_f32 v158, v158, v163
  v_mul_f32 v159, v159, v163
  v_cvt_pk_bf16_f32 v165, v158, v159
  v_lshlrev_b32 v158, 16, v165
  v_and_b32 v159, s44, v165
  v_pk_mul_f32 v[158:159], v[158:159], v[132:133]
  v_cvt_pk_bf16_f32 v165, v158, v159
  v_lshlrev_b32 v158, 16, v165
  v_and_b32 v159, s44, v165
  v_pk_add_f32 v[158:159], v[158:159], v[128:129]
  v_cvt_pk_bf16_f32 v158, v158, v159
  ds_write_b32 v21, v158
  s_waitcnt lgkmcnt(0)
  s_barrier
  ds_read_b128 v[168:171], v22 offset:0
  ds_read_b128 v[172:175], v22 offset:64
  ds_read_b128 v[176:179], v22 offset:128
  ds_read_b128 v[180:183], v22 offset:192
  ds_read_b128 v[184:187], v22 offset:256
  ds_read_b128 v[188:191], v22 offset:320
  ds_read_b128 v[192:195], v22 offset:384
  ds_read_b128 v[196:199], v22 offset:448
  ds_read_b128 v[200:203], v22 offset:512
  ds_read_b128 v[204:207], v22 offset:576
  ds_read_b128 v[208:211], v22 offset:640
  ds_read_b128 v[212:215], v22 offset:704
  ds_read_b128 v[216:219], v22 offset:768
  ds_read_b128 v[220:223], v22 offset:832
  ds_read_b128 v[224:227], v22 offset:896
  ds_read_b128 v[228:231], v22 offset:960
  s_waitcnt lgkmcnt(15)
  v_mfma_f32_16x16x32_bf16 v[150:153], v[32:35], v[168:171], 0
  s_waitcnt lgkmcnt(14)
  v_mfma_f32_16x16x32_bf16 v[150:153], v[36:39], v[172:175], v[150:153]
  s_waitcnt lgkmcnt(13)
  v_mfma_f32_16x16x32_bf16 v[150:153], v[40:43], v[176:179], v[150:153]
  s_waitcnt lgkmcnt(12)
  v_mfma_f32_16x16x32_bf16 v[150:153], v[44:47], v[180:183], v[150:153]
  s_waitcnt lgkmcnt(11)
  v_mfma_f32_16x16x32_bf16 v[150:153], v[48:51], v[184:187], v[150:153]
  s_waitcnt lgkmcnt(10)
  v_mfma_f32_16x16x32_bf16 v[150:153], v[52:55], v[188:191], v[150:153]
  s_waitcnt lgkmcnt(9)
  v_mfma_f32_16x16x32_bf16 v[150:153], v[56:59], v[192:195], v[150:153]
  s_waitcnt lgkmcnt(8)
  v_mfma_f32_16x16x32_bf16 v[150:153], v[60:63], v[196:199], v[150:153]
  s_waitcnt lgkmcnt(7)
  v_mfma_f32_16x16x32_bf16 v[150:153], v[64:67], v[200:203], v[150:153]
  s_waitcnt lgkmcnt(6)
  v_mfma_f32_16x16x32_bf16 v[150:153], v[68:71], v[204:207], v[150:153]
  s_waitcnt lgkmcnt(5)
  v_mfma_f32_16x16x32_bf16 v[150:153], v[72:75], v[208:211], v[150:153]
  s_waitcnt lgkmcnt(4)
  v_mfma_f32_16x16x32_bf16 v[150:153], v[76:79], v[212:215], v[150:153]
  s_waitcnt lgkmcnt(3)
  v_mfma_f32_16x16x32_bf16 v[150:153], v[80:83], v[216:219], v[150:153]
  s_waitcnt lgkmcnt(2)
  v_mfma_f32_16x16x32_bf16 v[150:153], v[84:87], v[220:223], v[150:153]
  s_waitcnt lgkmcnt(1)
  v_mfma_f32_16x16x32_bf16 v[150:153], v[88:91], v[224:227], v[150:153]
  s_waitcnt lgkmcnt(0)
  v_mfma_f32_16x16x32_bf16 v[150:153], v[92:95], v[228:231], v[150:153]
  s_nop 7
  v_permlane32_swap_b32 v150, v151
  v_permlane32_swap_b32 v152, v153
  v_cvt_pk_bf16_f32 v154, v150, v152
  v_lshlrev_b32 v150, 16, v154
  v_and_b32 v152, s44, v154
  v_cvt_pk_bf16_f32 v155, v151, v153
  v_lshlrev_b32 v151, 16, v155
  v_and_b32 v153, s44, v155
  v_mul_f32 v156, v150, v150
  v_mul_f32 v157, v152, v152
  v_mul_f32 v156, v156, v150
  v_mul_f32 v157, v157, v152
  v_fma_f32 v156, v156, v28, v150
  v_fma_f32 v157, v157, v28, v152
  v_mul_f32 v156, 0xc0135761, v156
  v_mul_f32 v157, 0xc0135761, v157
  v_exp_f32 v156, v156
  v_exp_f32 v157, v157
  v_add_f32 v156, 1.0, v156
  v_add_f32 v157, 1.0, v157
  v_rcp_f32 v156, v156
  v_rcp_f32 v157, v157
  v_mul_f32 v150, v150, v156
  v_mul_f32 v152, v152, v157
  v_cvt_pk_bf16_f32 v154, v150, v152
  v_lshlrev_b32 v150, 16, v154
  v_and_b32 v152, s44, v154
  v_mul_f32 v150, v150, v151
  v_mul_f32 v152, v152, v153
  v_cvt_pk_bf16_f32 v150, v150, v152
  s_mov_b64 exec, s[18:19]
  ds_write_b16 v23, v150
  ds_write_b16_d16_hi v23, v150 offset:4
  s_mov_b64 exec, -1
  s_waitcnt lgkmcnt(0)
  s_barrier
  ds_read_b128 v[168:171], v140
  ds_read_b128 v[172:175], v141
  ds_read_b128 v[176:179], v142
  ds_read_b128 v[180:183], v143
  ds_read_b128 v[184:187], v144
  ds_read_b128 v[188:191], v145
  ds_read_b128 v[192:195], v146
  ds_read_b128 v[196:199], v147
  s_waitcnt lgkmcnt(7)
  v_mfma_f32_16x16x32_bf16 v[150:153], v[96:99], v[168:171], 0
  s_waitcnt lgkmcnt(6)
  v_mfma_f32_16x16x32_bf16 v[150:153], v[100:103], v[172:175], v[150:153]
  s_waitcnt lgkmcnt(5)
  v_mfma_f32_16x16x32_bf16 v[150:153], v[104:107], v[176:179], v[150:153]
  s_waitcnt lgkmcnt(4)
  v_mfma_f32_16x16x32_bf16 v[150:153], v[108:111], v[180:183], v[150:153]
  s_waitcnt lgkmcnt(3)
  v_mfma_f32_16x16x32_bf16 v[150:153], v[112:115], v[184:187], v[150:153]
  s_waitcnt lgkmcnt(2)
  v_mfma_f32_16x16x32_bf16 v[150:153], v[116:119], v[188:191], v[150:153]
  s_waitcnt lgkmcnt(1)
  v_mfma_f32_16x16x32_bf16 v[150:153], v[120:123], v[192:195], v[150:153]
  s_waitcnt lgkmcnt(0)
  v_mfma_f32_16x16x32_bf16 v[150:153], v[124:127], v[196:199], v[150:153]
  s_nop 7
  v_perm_b32 v154, v150, v10, s40
  v_perm_b32 v155, v151, v10, s41
  v_perm_b32 v156, v152, v10, s42
  v_perm_b32 v157, v153, v10, s43
  s_mov_b32 exec_lo, 0x00ff00ff
  s_mov_b32 exec_hi, 0x00ff00ff
  global_store_dwordx4 v9, v[154:157], s[34:35] sc1
  s_mov_b64 exec, -1
  s_endpgm
L_exit:
  s_endpgm
L_bail_11:
  s_waitcnt vmcnt(0)
  s_branch L_pdone_10
L_bail_17:
  s_waitcnt vmcnt(0)
  s_branch L_pdone_16
L_bail_24:
  s_waitcnt vmcnt(0)
  s_branch L_pdone_23
L_bail_33:
  s_waitcnt vmcnt(0)
  s_branch L_pdone_31
L_bail_38:
  s_waitcnt vmcnt(0)
  s_branch L_pdone_37
L_bail_42:
  s_waitcnt vmcnt(0)
  s_branch L_pdone_41
L_bail_46:
  s_waitcnt vmcnt(0)
  s_branch L_pdone_45
L_bail_49:
  s_waitcnt vmcnt(0)
  s_branch L_pdone_48
L_codeend:
.section .rodata,"a"
.p2align 6
.amdhsa_kernel adaLN_cond__sliding_block_cached__glu_gated_geglu__decode_kernel
  .amdhsa_next_free_vgpr 256
  .amdhsa_next_free_sgpr 102
  .amdhsa_accum_offset 256
  .amdhsa_group_segment_fixed_size 0
  .amdhsa_kernarg_size 112
  .amdhsa_user_sgpr_count 2
  .amdhsa_user_sgpr_kernarg_segment_ptr 1
  .amdhsa_system_sgpr_workgroup_id_x 1
  .amdhsa_float_denorm_mode_32 3
.end_amdhsa_kernel
```
